```python
import torch

def _softmax(x, axis=-1):
    return torch.softmax(x, dim=axis)
def _gelu(x):
    return torch.nn.functional.gelu(x, approximate="tanh")
def _silu(x):
    return torch.nn.functional.silu(x)
def _sigmoid(x):
    return torch.sigmoid(x)
def _layernorm(x, axis=-1, eps=1e-5):
    m = x.mean(dim=axis, keepdim=True)
    v = x.var(dim=axis, keepdim=True, unbiased=False)
    return (x - m) / torch.sqrt(v + eps)
def _scatter_add(tgt, idx, src, axis=0):
    return tgt.clone().index_add_(axis, idx, src)
def _segment_sum(src, seg, n):
    out = torch.zeros((n,) + src.shape[1:], dtype=src.dtype)
    return out.index_add_(0, seg, src)
def _pad(x, pw):
    flat = tuple(v for pair in reversed(pw) for v in pair)
    return torch.nn.functional.pad(x, flat)

kernel_name = 'parallel_sum__mha_block__dense_activation_relu__prompt'

def setup_inputs():

    _w = (lambda a: (lambda t: t.to(torch.bfloat16) if t.is_floating_point() else t)(torch.as_tensor(a)))
    def _A_setup():
        B, S, D, H = 1, 2048, 640, 32
        return {
            "x": _w((lambda *s: torch.randn(*s, dtype=torch.bfloat16) * 0.05)(B, S, D)),
            "wqkv": _w((lambda *s: torch.randn(*s, dtype=torch.bfloat16) * 0.2)(D, 3 * D)),
            "wo": _w((lambda *s: torch.randn(*s, dtype=torch.bfloat16) * 0.1)(D, D)),
        }
    _A_in = _A_setup()

    def _B_setup():
        B, S, D, Dff = 1, 2048, 640, 1728
        return {
            "x": _w((lambda *s: torch.randn(*s, dtype=torch.bfloat16) * 0.05)(B, S, D)),
            "w1": _w((lambda *s: torch.randn(*s, dtype=torch.bfloat16) * 0.2)(D, Dff)),
            "w2": _w((lambda *s: torch.randn(*s, dtype=torch.bfloat16) * 0.2)(Dff, D)),
        }
    _B_in = _B_setup()

    return {
        "A_x": _A_in["x"],
        "A_wqkv": _A_in["wqkv"],
        "A_wo": _A_in["wo"],
        "B_x": _B_in["x"],
        "B_w1": _B_in["w1"],
        "B_w2": _B_in["w2"],
    }

def reference(A_x, A_wqkv, A_wo, B_x, B_w1, B_w2):
    def _A_ref(x, wqkv, wo):
        B, S, D = x.shape
        H = 32
        Dh = D // H
        qkv = (lambda x, *d: x.permute(*d))((x @ wqkv).reshape(B, S, 3, H, Dh), 2, 0, 3, 1, 4)
        q, k, v = qkv[0], qkv[1], qkv[2]
        scores = torch.einsum("bhqd,bhkd->bhqk", q, k) * (Dh ** -0.5)
        p = _softmax(scores, axis=-1)
        o = torch.einsum("bhqk,bhkd->bhqd", p, v)
        return (lambda x, *d: x.permute(*d))(o, 0, 2, 1, 3).reshape(B, S, D) @ wo

    def _B_ref(x, w1, w2):
        h = torch.einsum("bsd,df->bsf", x, w1)
        zero = torch.zeros_like(h)
        h = torch.maximum(h, zero)
        return torch.einsum("bsf,fd->bsd", h, w2)

    x = A_x
    xn = _layernorm(x, axis=-1)
    return x + _A_ref(xn, A_wqkv, A_wo) + _B_ref(xn, B_w1, B_w2)
```

```asm
; @launch grid=(256,1,1) block=(512,1,1) lds=163840
.amdgcn_target "amdgcn-amd-amdhsa--gfx950"
.text
.globl parallel_sum__mha_block__dense_activation_relu__prompt_kernel
.p2align 8
.type parallel_sum__mha_block__dense_activation_relu__prompt_kernel,@function
parallel_sum__mha_block__dense_activation_relu__prompt_kernel:
    s_cmp_ge_u32 s2, 0x100
    s_cbranch_scc1 L_END
    s_load_dwordx8 s[4:11], s[0:1], 0
    s_load_dwordx4 s[12:15], s[0:1], 32
    s_load_dwordx4 s[16:19], s[0:1], 48
    s_load_dwordx2 s[20:21], s[0:1], 64
    v_lshrrev_b32 v244, 6, v0
    v_and_b32 v1, 63, v0
    s_and_b32 s58, s2, 7
    s_lshr_b32 s59, s2, 3
    v_readfirstlane_b32 s48, v244
    s_and_b32 s60, s59, 7
    s_lshr_b32 s59, s59, 3
    s_lshr_b32 s49, s58, 1
    s_lshl_b32 s49, s49, 3
    s_or_b32 s49, s49, s60
    s_and_b32 s50, s58, 1
    s_lshl_b32 s50, s50, 2
    s_or_b32 s50, s50, s59
    s_cmp_ge_u32 s50, 5
    s_cselect_b32 s59, 5, 0
    s_sub_u32 s59, s50, s59
    s_add_u32 s59, s59, s60
    s_mul_i32 s60, s59, 52
    s_lshr_b32 s60, s60, 8
    s_mul_i32 s60, s60, 5
    s_sub_u32 s59, s59, s60
    s_lshl_b32 s52, s59, 1
    s_and_b32 s51, s48, 3
    v_bfe_u32 v244, v1, 2, 3
    v_mul_u32_u24 v244, 1280, v244
    v_lshrrev_b32 v245, 5, v1
    v_lshl_add_u32 v244, v245, 6, v244
    v_and_b32 v245, 3, v1
    v_lshlrev_b32 v245, 4, v245
    v_xor_b32 v246, 32, v245
    v_add_u32 v8, v244, v245
    v_add_u32 v246, v244, v246
    v_add_u32 v9, 9216, v246
    v_add_u32 v10, 18432, v8
    v_add_u32 v11, 27648, v246
    v_lshlrev_b32 v82, 4, v1
    v_cmp_gt_u32 vcc, 16, v1
    v_mov_b32 v244, 2147483648
    v_mov_b32 v15, 19070976
    v_cndmask_b32 v83, v244, v82, vcc
    s_lshl_b32 s81, s50, 5
    s_add_u32 s81, s81, s49
    s_lshl_b32 s81, s81, 3
    s_add_u32 s81, s81, s48
    s_mul_i32 s83, s81, 1280
    s_lshl_b32 s55, s50, 3
    s_add_u32 s55, s55, s48
    s_mul_i32 s55, s55, 40960
    s_lshl_b32 s69, s48, 12
    s_lshl_b32 s70, s51, 11
    s_mov_b32 s54, 0
    s_mul_i32 s63, s49, 40
    s_waitcnt lgkmcnt(0)
    s_mov_b32 s24, s4
    s_mov_b32 s25, s5
    s_mov_b32 s26, 2621440
    s_mov_b32 s27, 0x20000
    s_mov_b32 s36, s20
    s_mov_b32 s37, s21
    s_mov_b32 s38, 20971520
    s_mov_b32 s39, 0x20000
    buffer_load_dword v15, v15, s[36:39], 0 offen sc1
    buffer_load_dwordx4 v[84:87], v82, s[24:27], s83 offen
    buffer_load_dwordx4 v[88:91], v83, s[24:27], s83 offen offset:1024
    s_lshl_b32 s84, s81, 6
    s_lshl_b32 s58, s52, 7
    s_add_u32 m0, s54, s69
    s_add_u32 s58, s58, s55
    buffer_load_dwordx4 v8, s[24:27], s58 offen offset:0 lds
    buffer_load_dwordx4 v9, s[24:27], s58 offen offset:1024 lds
    buffer_load_dwordx4 v10, s[24:27], s58 offen offset:2048 lds
    buffer_load_dwordx4 v11, s[24:27], s58 offen offset:3072 lds
    s_cmp_ge_u32 s48, 4
    s_cbranch_scc1 L_B0
    s_add_u32 s70, s70, 32768
    s_mov_b32 s56, 245760
    s_lshl_b32 s58, s51, 7
    v_add_u32 v244, s58, v1
    s_mov_b32 s60, 173136
    s_mov_b32 s61, 147336
    v_mul_u32_u24 v245, 7282, v244
    v_lshrrev_b32 v245, 16, v245
    v_mul_u32_u24 v246, 9, v245
    v_sub_u32 v244, v244, v246
    v_lshlrev_b32 v244, 1, v244
    v_and_b32 v246, 1, v245
    v_bfe_u32 v247, v245, 1, 2
    v_and_b32 v245, 0x38, v245
    v_lshl_add_u32 v245, v246, 2, v245
    v_add_u32 v245, v245, v247
    v_mul_u32_u24 v245, 3840, v245
    v_bfe_u32 v246, s60, v244, 2
    v_mul_u32_u24 v246, 1280, v246
    v_bfe_u32 v244, s61, v244, 2
    v_lshl_add_u32 v244, v244, 3, v245
    v_add3_u32 v12, v244, v246, s63
    s_add_u32 s58, s58, 64
    v_add_u32 v244, s58, v1
    s_mov_b32 s60, 173136
    s_mov_b32 s61, 147336
    v_mul_u32_u24 v245, 7282, v244
    v_lshrrev_b32 v245, 16, v245
    v_mul_u32_u24 v246, 9, v245
    v_sub_u32 v244, v244, v246
    v_lshlrev_b32 v244, 1, v244
    v_and_b32 v246, 1, v245
    v_bfe_u32 v247, v245, 1, 2
    v_and_b32 v245, 0x38, v245
    v_lshl_add_u32 v245, v246, 2, v245
    v_add_u32 v245, v245, v247
    v_mul_u32_u24 v245, 3840, v245
    v_bfe_u32 v246, s60, v244, 2
    v_mul_u32_u24 v246, 1280, v246
    v_bfe_u32 v244, s61, v244, 2
    v_lshl_add_u32 v244, v244, 3, v245
    v_add3_u32 v13, v244, v246, s63
    v_subrev_u32 v13, 1024, v13
    s_mov_b32 s28, s6
    s_mov_b32 s29, s7
    s_mov_b32 s30, 2457600
    s_mov_b32 s31, 0x20000
    s_add_u32 m0, s54, s70
    s_mul_i32 s59, s52, s56
    buffer_load_dwordx4 v12, s[28:31], s59 offen lds
    buffer_load_dwordx4 v13, s[28:31], s59 offen offset:1024 lds
    s_add_u32 s52, s52, 1
    s_cmp_eq_u32 s52, 10
    s_cselect_b32 s52, 0, s52
    s_add_u32 s54, s54, 50176
    s_cmp_eq_u32 s54, 150528
    s_cselect_b32 s54, 0, s54
    s_branch L_A
L_B0:
    s_lshl_b32 s58, 1, s49
    s_sub_u32 s58, s58, 1
    s_and_b32 s58, s58, 3988254135
    s_bcnt1_i32_b32 s62, s58
    s_cmp_ge_u32 s62, 6
    s_addc_u32 s62, s62, 0
    s_cmp_ge_u32 s62, 13
    s_addc_u32 s62, s62, 0
    s_cmp_eq_u32 s49, 6
    s_cselect_b32 s62, 6, s62
    s_cmp_eq_u32 s49, 12
    s_cselect_b32 s62, 13, s62
    s_cmp_eq_u32 s49, 22
    s_cselect_b32 s62, 26, s62
    s_add_u32 s70, s70, 41984
    s_mov_b32 s56, 221184
    s_lshl_b32 s71, s51, 8
    s_add_u32 s71, s71, 40960
    s_mul_i32 s58, s51, 55296
    s_lshl_b32 s59, s62, 7
    s_add_u32 s58, s58, s59
    v_lshrrev_b32 v244, 3, v1
    v_mul_u32_u24 v244, 3456, v244
    v_and_b32 v245, 7, v1
    v_bfe_u32 v246, v1, 4, 1
    v_lshlrev_b32 v246, 1, v246
    v_xor_b32 v245, v245, v246
    v_lshlrev_b32 v245, 4, v245
    v_add3_u32 v12, v244, v245, s58
    v_xor_b32 v245, 64, v245
    s_add_u32 s58, s58, 26624
    v_add3_u32 v13, v244, v245, s58
    s_lshl_b32 s58, s51, 4
    s_add_u32 s58, s58, 512
    v_add_u32 v244, s58, v1
    s_mov_b32 s60, 173136
    s_mov_b32 s61, 147336
    v_mul_u32_u24 v245, 7282, v244
    v_lshrrev_b32 v245, 16, v245
    v_mul_u32_u24 v246, 9, v245
    v_sub_u32 v244, v244, v246
    v_lshlrev_b32 v244, 1, v244
    v_and_b32 v246, 1, v245
    v_bfe_u32 v247, v245, 1, 2
    v_and_b32 v245, 0x38, v245
    v_lshl_add_u32 v245, v246, 2, v245
    v_add_u32 v245, v245, v247
    v_mul_u32_u24 v245, 3840, v245
    v_bfe_u32 v246, s60, v244, 2
    v_mul_u32_u24 v246, 1280, v246
    v_bfe_u32 v244, s61, v244, 2
    v_lshl_add_u32 v244, v244, 3, v245
    v_add3_u32 v14, v244, v246, s63
    s_mov_b32 s28, s12
    s_mov_b32 s29, s13
    s_mov_b32 s30, 2211840
    s_mov_b32 s31, 0x20000
    s_mov_b32 s32, s6
    s_mov_b32 s33, s7
    s_mov_b32 s34, 2457600
    s_mov_b32 s35, 0x20000
    s_bitcmp1_b32 3992452599, s49
    s_cselect_b32 s30, s30, 0
    s_add_u32 m0, s54, s70
    s_mul_i32 s59, s52, s56
    buffer_load_dwordx4 v12, s[28:31], s59 offen lds
    buffer_load_dwordx4 v13, s[28:31], s59 offen offset:1024 lds
    s_add_u32 m0, s54, s71
    s_mul_i32 s59, s52, 245760
    s_mov_b64 exec, 0xffff
    buffer_load_dwordx4 v14, s[32:35], s59 offen lds
    s_mov_b64 exec, -1
    s_add_u32 s52, s52, 1
    s_cmp_eq_u32 s52, 10
    s_cselect_b32 s52, 0, s52
    s_add_u32 s54, s54, 50176
    s_cmp_eq_u32 s54, 150528
    s_cselect_b32 s54, 0, s54
    s_branch L_B
L_A:
    s_getpc_b64 s[44:45]
L_PC:
    s_sub_u32 s44, s44, L_PC-parallel_sum__mha_block__dense_activation_relu__prompt_kernel
    s_subb_u32 s45, s45, 0
    s_mov_b32 s46, L_END-parallel_sum__mha_block__dense_activation_relu__prompt_kernel
    s_mov_b32 s47, 0x20000
    s_lshr_b32 s58, s2, 3
    s_lshl_b32 s58, s58, 2
    s_add_u32 s58, s58, s51
    s_lshl_b32 s58, s58, 7
    v_lshlrev_b32 v16, 14, v1
    buffer_load_dword v17, v16, s[44:47], s58 offen
    s_mov_b32 s66, 0xffff0000
    s_mov_b32 s67, 0
    s_mov_b32 s53, 10
    s_mov_b32 s76, 0
    v_cmp_gt_u32 s[72:73], 32, v1
    v_lshlrev_b32 v244, 2, v0
    v_mov_b32 v246, 0xff800000
    v_cmp_gt_u32 vcc, 1024, v244
    v_min_u32 v245, 1276, v244
    v_add_u32 v245, 157696, v245
    v_cndmask_b32 v246, 0, v246, vcc
    ds_write_b32 v245, v246
    v_mov_b32 v96, 0
    v_mov_b32 v97, 0
    v_mov_b32 v62, 0x3f803f80
    v_mov_b32 v63, 0x3f803f80
    v_mfma_f32_32x32x8_bf16 v[130:145], v[96:97], v[96:97], 0
    v_mfma_f32_32x32x8_bf16 v[146:161], v[96:97], v[96:97], 0
    v_mfma_f32_32x32x8_bf16 v[162:177], v[96:97], v[96:97], 0
    v_mfma_f32_32x32x8_bf16 v[178:193], v[96:97], v[96:97], 0
    v_mfma_f32_32x32x8_bf16 v[98:113], v[96:97], v[96:97], 0
    v_mfma_f32_32x32x8_bf16 v[114:129], v[96:97], v[96:97], 0
    v_mfma_f32_32x32x8_bf16 v[20:35], v[96:97], v[96:97], 0
    v_and_b32 v244, 15, v1
    v_lshrrev_b32 v245, 4, v1
    v_bfe_u32 v246, v1, 3, 1
    v_lshlrev_b32 v247, 1, v246
    v_xor_b32 v247, v247, v245
    v_lshlrev_b32 v247, 4, v247
    v_lshl_add_u32 v247, v246, 10, v247
    v_and_b32 v246, 7, v1
    v_lshl_add_u32 v247, v246, 6, v247
    s_lshl_b32 s58, s51, 13
    v_add_u32 v2, s58, v247
    s_lshl_b32 s58, s48, 8
    s_add_u32 s58, s58, 126976
    v_lshl_add_u32 v64, v1, 2, s58
    v_lshl_add_u32 v65, v245, 4, s58
    s_lshl_b32 s58, s50, 2
    s_add_u32 s58, s58, s51
    s_lshl_b32 s58, s58, 12
    s_add_u32 s58, s58, 19136512
    v_lshl_add_u32 v82, v244, 6, s58
    s_mul_i32 s58, s49, 5120
    s_add_u32 s58, s58, 19267584
    v_lshl_add_u32 v83, v1, 3, s58
    v_bfe_u32 v246, v1, 2, 2
    v_and_b32 v247, 3, v1
    v_lshl_add_u32 v248, v245, 2, v246
    v_mul_u32_u24 v248, 288, v248
    v_add_u32 v248, 32768, v248
    v_lshl_add_u32 v3, v247, 3, v248
    s_mov_b32 s58, 0x8db9
    v_lshlrev_b32 v247, 2, v247
    v_bfe_u32 v247, s58, v247, 4
    v_lshl_add_u32 v4, v247, 3, v248
    v_and_b32 v244, 31, v1
    v_lshrrev_b32 v245, 5, v1
    v_cmp_gt_u32 s[74:75], 20, v244
    v_cmp_gt_u32 vcc, 21, v244
    v_lshlrev_b32 v226, 4, v1
    v_mul_u32_u24 v246, 24, v245
    v_add_u32 v246, v246, v244
    v_lshlrev_b32 v246, 4, v246
    v_add_u32 v246, 1024, v246
    v_mov_b32 v248, 2147483648
    v_cndmask_b32 v227, v248, v246, vcc
    v_cmp_gt_u32 vcc, 24, v244
    v_min_u32 v228, 32, v1
    v_lshlrev_b32 v228, 3, v228
    v_cndmask_b32 v69, v248, v246, vcc
    v_cmp_gt_u32 vcc, 40, v1
    v_lshlrev_b32 v246, 3, v1
    v_add_u32 v246, 2560, v246
    v_cndmask_b32 v70, v248, v246, vcc
    v_add_u32 v228, 2560, v228
    v_mov_b32 v229, 0xdddddddd
    v_mov_b32 v252, 0
    v_mov_b32 v253, 0
    v_cmp_eq_u32 vcc, 20, v244
    v_mov_b32 v247, 0x3f803f80
    s_nop 0
    v_cndmask_b32 v73, 0, v247, vcc
    s_mul_i32 s58, s51, 2560
    s_add_u32 s58, s58, 114688
    v_mul_u32_u24 v246, 40, v244
    v_add_u32 v66, s58, v246
    s_lshl_b32 s59, s51, 10
    s_add_u32 s59, s59, 110592
    v_lshl_add_u32 v67, v1, 3, s59
    v_and_b32 v246, 15, v1
    v_mul_u32_u24 v246, 40, v246
    v_lshrrev_b32 v247, 4, v1
    v_lshl_add_u32 v246, v247, 3, v246
    v_add_u32 v68, s58, v246
    v_cmp_gt_u32 s[22:23], 16, v1
    s_mov_b32 s59, 0x43210
    v_bfe_u32 v246, v1, 4, 1
    v_and_b32 v247, 3, v1
    v_lshl_add_u32 v246, v246, 2, v247
    v_lshlrev_b32 v246, 2, v246
    v_bfe_u32 v246, s59, v246, 4
    v_bfe_u32 v247, v1, 2, 2
    v_lshl_add_u32 v247, v245, 3, v247
    v_mul_u32_u24 v247, 40, v247
    v_lshl_add_u32 v246, v246, 3, v247
    v_add_u32 v71, s58, v246
    s_lshl_b32 s59, s51, 11
    s_add_u32 s59, s59, 102400
    v_add_u32 v72, s59, v226
    s_xor_b32 s58, s51, 3
    s_lshl_b32 s59, s58, 11
    s_add_u32 s59, s59, 102400
    v_add_u32 v74, s59, v226
    s_lshl_b32 s59, s58, 10
    s_add_u32 s59, s59, 110592
    v_lshl_add_u32 v78, v1, 3, s59
    s_lshl_b32 s59, s58, 8
    s_add_u32 s59, s59, 157696
    v_lshl_add_u32 v238, v244, 2, s59
    s_xor_b32 s58, s51, 2
    s_lshl_b32 s59, s58, 11
    s_add_u32 s59, s59, 102400
    v_add_u32 v75, s59, v226
    s_lshl_b32 s59, s58, 10
    s_add_u32 s59, s59, 110592
    v_lshl_add_u32 v79, v1, 3, s59
    s_lshl_b32 s59, s58, 8
    s_add_u32 s59, s59, 157696
    v_lshl_add_u32 v239, v244, 2, s59
    s_xor_b32 s58, s51, 1
    s_lshl_b32 s59, s58, 11
    s_add_u32 s59, s59, 102400
    v_add_u32 v76, s59, v226
    s_lshl_b32 s59, s58, 10
    s_add_u32 s59, s59, 110592
    v_lshl_add_u32 v80, v1, 3, s59
    s_lshl_b32 s59, s58, 8
    s_add_u32 s59, s59, 157696
    v_lshl_add_u32 v240, v244, 2, s59
    s_xor_b32 s58, s51, 0
    s_lshl_b32 s59, s58, 11
    s_add_u32 s59, s59, 102400
    v_add_u32 v77, s59, v226
    s_lshl_b32 s59, s58, 10
    s_add_u32 s59, s59, 110592
    v_lshl_add_u32 v81, v1, 3, s59
    s_lshl_b32 s59, s58, 8
    s_add_u32 s59, s59, 157696
    v_lshl_add_u32 v241, v244, 2, s59
    s_xor_b32 s58, s51, 0
    s_mul_i32 s59, s58, 12288
    s_add_u32 s59, s59, 102400
    v_add_u32 v234, s59, v226
    s_xor_b32 s58, s51, 2
    s_mul_i32 s59, s58, 12288
    s_add_u32 s59, s59, 102400
    v_add_u32 v235, s59, v226
    s_xor_b32 s58, s51, 3
    s_mul_i32 s59, s58, 12288
    s_add_u32 s59, s59, 102400
    v_add_u32 v236, s59, v226
    s_lshl_b32 s58, s49, 2
    s_add_u32 s58, s58, s51
    s_lshl_b32 s58, s58, 9
    s_add_u32 s58, s58, 18874368
    v_and_b32 v230, 7, v1
    v_lshl_add_u32 v230, v230, 6, s58
    s_lshl_b32 s59, s50, 6
    s_add_u32 s85, s58, s59
    s_lshl_b32 s58, s49, 2
    s_add_u32 s58, s58, s51
    s_lshl_b32 s58, s58, 16
    s_lshl_b32 s80, s50, 13
    v_add_u32 v226, s58, v226
    v_add_u32 v227, s58, v227
    v_add_u32 v228, s58, v228
    v_add_u32 v69, s58, v69
    v_add_u32 v70, s58, v70
    v_bfe_u32 v246, v1, 4, 1
    v_mul_u32_u24 v246, 20480, v246
    v_and_b32 v247, 15, v1
    v_lshl_add_u32 v242, v247, 4, v246
    v_lshl_add_u32 v242, v245, 8, v242
    v_lshl_add_u32 v246, v247, 3, v246
    v_cndmask_b32 v243, v248, v246, s[72:73]
    s_lshl_b32 s59, s50, 2
    s_add_u32 s59, s59, s51
    s_mul_i32 s60, s59, 81920
    s_add_u32 s60, s60, 15728640
    s_lshl_b32 s61, s49, 9
    s_add_u32 s87, s60, s61
    s_lshl_b32 s61, s49, 7
    s_add_u32 s61, s61, 16384
    s_add_u32 s88, s60, s61
    s_lshl_b32 s59, s59, 11
    s_lshl_b32 s60, s49, 6
    s_add_u32 s59, s59, s60
    s_add_u32 s86, s59, 19005440
    s_lshl_b32 s59, s51, 3
    s_add_u32 s89, s59, 158752
    s_mov_b32 s100, 0
    s_mov_b32 s77, 0
    s_mov_b32 s78, 0
    s_waitcnt vmcnt(7)
    v_readfirstlane_b32 s64, v15
    v_mov_b32 v244, 0
    v_mov_b32 v245, 0
    v_dot2_f32_bf16 v244, v84, v62, v244
    v_dot2_f32_bf16 v245, v84, v84, v245
    v_dot2_f32_bf16 v244, v85, v62, v244
    v_dot2_f32_bf16 v245, v85, v85, v245
    v_dot2_f32_bf16 v244, v86, v62, v244
    v_dot2_f32_bf16 v245, v86, v86, v245
    v_dot2_f32_bf16 v244, v87, v62, v244
    v_dot2_f32_bf16 v245, v87, v87, v245
    v_dot2_f32_bf16 v244, v88, v62, v244
    v_dot2_f32_bf16 v245, v88, v88, v245
    v_dot2_f32_bf16 v244, v89, v62, v244
    v_dot2_f32_bf16 v245, v89, v89, v245
    v_dot2_f32_bf16 v244, v90, v62, v244
    v_dot2_f32_bf16 v245, v90, v90, v245
    v_dot2_f32_bf16 v244, v91, v62, v244
    v_dot2_f32_bf16 v245, v91, v91, v245
    s_add_u32 s64, s64, 1
    s_not_b32 s65, s64
    s_nop 1
    v_add_f32_dpp v244, v244, v244 row_shr:1 bound_ctrl:0
    v_add_f32_dpp v245, v245, v245 row_shr:1 bound_ctrl:0
    s_nop 0
    v_add_f32_dpp v244, v244, v244 row_shr:2 bound_ctrl:0
    v_add_f32_dpp v245, v245, v245 row_shr:2 bound_ctrl:0
    s_nop 0
    v_add_f32_dpp v244, v244, v244 row_shr:4 bound_ctrl:0
    v_add_f32_dpp v245, v245, v245 row_shr:4 bound_ctrl:0
    s_nop 0
    v_add_f32_dpp v244, v244, v244 row_shr:8 bound_ctrl:0
    v_add_f32_dpp v245, v245, v245 row_shr:8 bound_ctrl:0
    s_nop 0
    v_add_f32_dpp v244, v244, v244 row_bcast:15 row_mask:0xa
    v_add_f32_dpp v245, v245, v245 row_bcast:15 row_mask:0xa
    s_nop 0
    v_add_f32_dpp v244, v244, v244 row_bcast:31 row_mask:0xc
    v_add_f32_dpp v245, v245, v245 row_bcast:31 row_mask:0xc
    s_nop 0
    s_mov_b32 s58, 986500301
    v_mul_f32 v244, s58, v244
    v_mul_f32 v245, s58, v245
    v_fma_f32 v245, -v244, v244, v245
    v_max_f32 v245, 0, v245
    v_add_f32 v245, 925353388, v245
    v_rsq_f32 v245, v245
    v_readlane_b32 s58, v244, 63
    s_add_u32 s84, s84, 19136512
    v_readlane_b32 s59, v245, 63
    s_mov_b64 exec, 15
    v_mov_b32 v246, s64
    v_mov_b32 v247, s65
    v_lshlrev_b32 v248, 4, v1
    v_mov_b32 v244, s58
    v_mov_b32 v245, s59
    buffer_store_dwordx4 v[244:247], v248, s[36:39], s84 offen sc1
    s_mov_b64 exec, -1
    s_lshl_b32 s58, s52, 7
    s_add_u32 m0, s54, s69
    s_add_u32 s58, s58, s55
    buffer_load_dwordx4 v8, s[24:27], s58 offen offset:0 lds
    buffer_load_dwordx4 v9, s[24:27], s58 offen offset:1024 lds
    buffer_load_dwordx4 v10, s[24:27], s58 offen offset:2048 lds
    buffer_load_dwordx4 v11, s[24:27], s58 offen offset:3072 lds
    s_add_u32 m0, s54, s70
    s_mul_i32 s59, s52, s56
    buffer_load_dwordx4 v12, s[28:31], s59 offen lds
    buffer_load_dwordx4 v13, s[28:31], s59 offen offset:1024 lds
    s_add_u32 s52, s52, 1
    s_cmp_eq_u32 s52, 10
    s_cselect_b32 s52, 0, s52
    s_add_u32 s54, s54, 50176
    s_cmp_eq_u32 s54, 150528
    s_cselect_b32 s54, 0, s54
    s_cmp_lt_u32 s50, 5
    s_cselect_b32 s58, s51, 7
    s_waitcnt vmcnt(8) lgkmcnt(0)
    s_barrier
    s_cmp_eq_u32 s58, 0
    s_cbranch_scc0 L_P1a_in
    s_branch L_P1a_hin
L_P1a_h:
    s_waitcnt vmcnt(6) lgkmcnt(0)
    s_barrier
L_P1a_hin:
    v_mfma_f32_16x16x32_bf16 v[130:133], v[114:117], v[98:101], v[130:133]
    ds_read_b128 v[194:197], v2 offset:0
    s_setprio 0
    v_mfma_f32_16x16x32_bf16 v[134:137], v[118:121], v[98:101], v[134:137]
    ds_read_b64_tr_b16 v[210:211], v3 offset:0
    v_mfma_f32_4x4x4_16b_bf16 v[20:23], v[62:63], v[114:115], v[20:23]
    v_mfma_f32_16x16x32_bf16 v[138:141], v[122:125], v[98:101], v[138:141]
    ds_read_b64_tr_b16 v[212:213], v3 offset:144
    s_lshl_b32 s58, s52, 7
    s_add_u32 m0, s54, s69
    s_add_u32 s58, s58, s55
    buffer_load_dwordx4 v8, s[24:27], s58 offen offset:0 lds
    v_mfma_f32_16x16x32_bf16 v[142:145], v[126:129], v[98:101], v[142:145]
    ds_read_b128 v[198:201], v2 offset:2048
    v_mfma_f32_4x4x4_16b_bf16 v[24:27], v[62:63], v[118:119], v[24:27]
    v_mfma_f32_16x16x32_bf16 v[158:161], v[126:129], v[102:105], v[158:161]
    ds_read_b64_tr_b16 v[214:215], v3 offset:32
    v_mfma_f32_16x16x32_bf16 v[154:157], v[122:125], v[102:105], v[154:157]
    ds_read_b64_tr_b16 v[216:217], v3 offset:176
    v_mfma_f32_4x4x4_16b_bf16 v[28:31], v[62:63], v[122:123], v[28:31]
    v_mfma_f32_16x16x32_bf16 v[150:153], v[118:121], v[102:105], v[150:153]
    ds_read_b128 v[202:205], v2 offset:4096
    s_add_u32 s61, s67, 50176
    s_cmp_eq_u32 s61, 150528
    s_cselect_b32 s61, 0, s61
    s_sub_u32 s68, s61, s67
    s_mov_b32 s67, s61
    v_mfma_f32_16x16x32_bf16 v[146:149], v[114:117], v[102:105], v[146:149]
    ds_read_b64_tr_b16 v[218:219], v3 offset:112
    v_mfma_f32_4x4x4_16b_bf16 v[32:35], v[62:63], v[126:127], v[32:35]
    v_mfma_f32_16x16x32_bf16 v[162:165], v[114:117], v[106:109], v[162:165]
    ds_read_b64_tr_b16 v[220:221], v3 offset:256
    buffer_load_dwordx4 v9, s[24:27], s58 offen offset:1024 lds
    v_mfma_f32_16x16x32_bf16 v[166:169], v[118:121], v[106:109], v[166:169]
    ds_read_b128 v[206:209], v2 offset:6144
    v_mfma_f32_4x4x4_16b_bf16 v[20:23], v[62:63], v[116:117], v[20:23]
    v_mfma_f32_16x16x32_bf16 v[170:173], v[122:125], v[106:109], v[170:173]
    ds_read_b64_tr_b16 v[222:223], v4 offset:0
    v_mfma_f32_16x16x32_bf16 v[174:177], v[126:129], v[106:109], v[174:177]
    ds_read_b64_tr_b16 v[224:225], v4 offset:144
    v_mfma_f32_4x4x4_16b_bf16 v[24:27], v[62:63], v[120:121], v[24:27]
    v_mfma_f32_16x16x32_bf16 v[190:193], v[126:129], v[110:113], v[190:193]
    buffer_load_dwordx4 v10, s[24:27], s58 offen offset:2048 lds
    v_mfma_f32_16x16x32_bf16 v[186:189], v[122:125], v[110:113], v[186:189]
    v_mfma_f32_4x4x4_16b_bf16 v[28:31], v[62:63], v[124:125], v[28:31]
    v_mfma_f32_16x16x32_bf16 v[182:185], v[118:121], v[110:113], v[182:185]
    v_mfma_f32_16x16x32_bf16 v[178:181], v[114:117], v[110:113], v[178:181]
    v_mfma_f32_4x4x4_16b_bf16 v[32:35], v[62:63], v[128:129], v[32:35]
    s_waitcnt lgkmcnt(0)
    v_mfma_f32_16x16x32_bf16 v[130:133], v[210:213], v[194:197], v[130:133]
    ds_read_b128 v[98:101], v2 offset:512
    s_setprio 1
    v_mfma_f32_16x16x32_bf16 v[134:137], v[214:217], v[194:197], v[134:137]
    ds_read_b64_tr_b16 v[114:115], v3 offset:4608
    v_mfma_f32_4x4x4_16b_bf16 v[20:23], v[62:63], v[210:211], v[20:23]
    v_mfma_f32_16x16x32_bf16 v[138:141], v[218:221], v[194:197], v[138:141]
    ds_read_b64_tr_b16 v[116:117], v3 offset:4752
    buffer_load_dwordx4 v11, s[24:27], s58 offen offset:3072 lds
    v_mfma_f32_16x16x32_bf16 v[142:145], v[222:225], v[194:197], v[142:145]
    ds_read_b128 v[102:105], v2 offset:2560
    v_mfma_f32_4x4x4_16b_bf16 v[24:27], v[62:63], v[214:215], v[24:27]
    v_mfma_f32_16x16x32_bf16 v[158:161], v[222:225], v[198:201], v[158:161]
    ds_read_b64_tr_b16 v[118:119], v3 offset:4640
    v_mfma_f32_16x16x32_bf16 v[154:157], v[218:221], v[198:201], v[154:157]
    ds_read_b64_tr_b16 v[120:121], v3 offset:4784
    v_mfma_f32_4x4x4_16b_bf16 v[28:31], v[62:63], v[218:219], v[28:31]
    v_mfma_f32_16x16x32_bf16 v[150:153], v[214:217], v[198:201], v[150:153]
    ds_read_b128 v[106:109], v2 offset:4608
    s_add_u32 m0, s54, s70
    s_mul_i32 s59, s52, s56
    buffer_load_dwordx4 v12, s[28:31], s59 offen lds
    v_mfma_f32_16x16x32_bf16 v[146:149], v[210:213], v[198:201], v[146:149]
    ds_read_b64_tr_b16 v[122:123], v3 offset:4720
    v_mfma_f32_4x4x4_16b_bf16 v[32:35], v[62:63], v[222:223], v[32:35]
    v_mfma_f32_16x16x32_bf16 v[162:165], v[210:213], v[202:205], v[162:165]
    ds_read_b64_tr_b16 v[124:125], v3 offset:4864
    v_mfma_f32_16x16x32_bf16 v[166:169], v[214:217], v[202:205], v[166:169]
    ds_read_b128 v[110:113], v2 offset:6656
    v_mfma_f32_4x4x4_16b_bf16 v[20:23], v[62:63], v[212:213], v[20:23]
    v_mfma_f32_16x16x32_bf16 v[170:173], v[218:221], v[202:205], v[170:173]
    ds_read_b64_tr_b16 v[126:127], v4 offset:4608
    buffer_load_dwordx4 v13, s[28:31], s59 offen offset:1024 lds
    v_mfma_f32_16x16x32_bf16 v[174:177], v[222:225], v[202:205], v[174:177]
    ds_read_b64_tr_b16 v[128:129], v4 offset:4752
    v_mfma_f32_4x4x4_16b_bf16 v[24:27], v[62:63], v[216:217], v[24:27]
    v_mfma_f32_16x16x32_bf16 v[190:193], v[222:225], v[206:209], v[190:193]
    v_add_u32 v2, s68, v2
    v_add_u32 v3, s68, v3
    v_mfma_f32_16x16x32_bf16 v[186:189], v[218:221], v[206:209], v[186:189]
    s_add_u32 s52, s52, 1
    s_cmp_eq_u32 s52, 10
    s_cselect_b32 s52, 0, s52
    s_add_u32 s54, s54, 50176
    s_cmp_eq_u32 s54, 150528
    s_cselect_b32 s54, 0, s54
    v_add_u32 v4, s68, v4
    v_mfma_f32_4x4x4_16b_bf16 v[28:31], v[62:63], v[220:221], v[28:31]
    v_mfma_f32_16x16x32_bf16 v[182:185], v[214:217], v[206:209], v[182:185]
    s_sub_u32 s53, s53, 1
    s_cmp_gt_u32 s53, 8
    v_mfma_f32_16x16x32_bf16 v[178:181], v[210:213], v[206:209], v[178:181]
    v_mfma_f32_4x4x4_16b_bf16 v[32:35], v[62:63], v[224:225], v[32:35]
    s_cbranch_scc1 L_P1a_h
    s_waitcnt lgkmcnt(0)
    v_mfma_f32_4x4x4_16b_bf16 v[20:23], v[62:63], v[114:115], v[20:23]
    v_mfma_f32_4x4x4_16b_bf16 v[24:27], v[62:63], v[118:119], v[24:27]
    v_mfma_f32_4x4x4_16b_bf16 v[28:31], v[62:63], v[122:123], v[28:31]
    v_mfma_f32_4x4x4_16b_bf16 v[32:35], v[62:63], v[126:127], v[32:35]
    v_mfma_f32_4x4x4_16b_bf16 v[20:23], v[62:63], v[116:117], v[20:23]
    v_mfma_f32_4x4x4_16b_bf16 v[24:27], v[62:63], v[120:121], v[24:27]
    v_mfma_f32_4x4x4_16b_bf16 v[28:31], v[62:63], v[124:125], v[28:31]
    v_mfma_f32_4x4x4_16b_bf16 v[32:35], v[62:63], v[128:129], v[32:35]
    s_lshl_b32 s58, s50, 9
    v_mov_b32 v245, s64
    s_nop 2
    v_permlane16_swap_b32 v20, v24
    v_permlane16_swap_b32 v28, v32
    v_add_f32 v20, v20, v24
    v_add_f32 v28, v28, v32
    s_nop 1
    v_permlane32_swap_b32 v20, v28
    v_add_f32 v244, v20, v28
    buffer_store_dwordx2 v[244:245], v83, s[36:39], s58 offen sc1
.p2align 3
L_P1a:
    s_waitcnt vmcnt(6) lgkmcnt(0)
    s_barrier
L_P1a_in:
    v_mfma_f32_16x16x32_bf16 v[130:133], v[114:117], v[98:101], v[130:133]
    ds_read_b128 v[194:197], v2 offset:0
    s_setprio 0
    v_mfma_f32_16x16x32_bf16 v[134:137], v[118:121], v[98:101], v[134:137]
    ds_read_b64_tr_b16 v[210:211], v3 offset:0
    v_mfma_f32_16x16x32_bf16 v[138:141], v[122:125], v[98:101], v[138:141]
    ds_read_b64_tr_b16 v[212:213], v3 offset:144
    s_lshl_b32 s58, s52, 7
    s_add_u32 m0, s54, s69
    s_add_u32 s58, s58, s55
    buffer_load_dwordx4 v8, s[24:27], s58 offen offset:0 lds
    v_mfma_f32_16x16x32_bf16 v[142:145], v[126:129], v[98:101], v[142:145]
    ds_read_b128 v[198:201], v2 offset:2048
    v_mfma_f32_16x16x32_bf16 v[158:161], v[126:129], v[102:105], v[158:161]
    ds_read_b64_tr_b16 v[214:215], v3 offset:32
    v_mfma_f32_16x16x32_bf16 v[154:157], v[122:125], v[102:105], v[154:157]
    ds_read_b64_tr_b16 v[216:217], v3 offset:176
    v_mfma_f32_16x16x32_bf16 v[150:153], v[118:121], v[102:105], v[150:153]
    ds_read_b128 v[202:205], v2 offset:4096
    s_add_u32 s61, s67, 50176
    s_cmp_eq_u32 s61, 150528
    s_cselect_b32 s61, 0, s61
    s_sub_u32 s68, s61, s67
    s_mov_b32 s67, s61
    v_mfma_f32_16x16x32_bf16 v[146:149], v[114:117], v[102:105], v[146:149]
    ds_read_b64_tr_b16 v[218:219], v3 offset:112
    v_mfma_f32_16x16x32_bf16 v[162:165], v[114:117], v[106:109], v[162:165]
    ds_read_b64_tr_b16 v[220:221], v3 offset:256
    buffer_load_dwordx4 v9, s[24:27], s58 offen offset:1024 lds
    v_mfma_f32_16x16x32_bf16 v[166:169], v[118:121], v[106:109], v[166:169]
    ds_read_b128 v[206:209], v2 offset:6144
    v_mfma_f32_16x16x32_bf16 v[170:173], v[122:125], v[106:109], v[170:173]
    ds_read_b64_tr_b16 v[222:223], v4 offset:0
    v_mfma_f32_16x16x32_bf16 v[174:177], v[126:129], v[106:109], v[174:177]
    ds_read_b64_tr_b16 v[224:225], v4 offset:144
    v_mfma_f32_16x16x32_bf16 v[190:193], v[126:129], v[110:113], v[190:193]
    buffer_load_dwordx4 v10, s[24:27], s58 offen offset:2048 lds
    v_mfma_f32_16x16x32_bf16 v[186:189], v[122:125], v[110:113], v[186:189]
    v_mfma_f32_16x16x32_bf16 v[182:185], v[118:121], v[110:113], v[182:185]
    v_mfma_f32_16x16x32_bf16 v[178:181], v[114:117], v[110:113], v[178:181]
    s_waitcnt lgkmcnt(0)
    v_mfma_f32_16x16x32_bf16 v[130:133], v[210:213], v[194:197], v[130:133]
    ds_read_b128 v[98:101], v2 offset:512
    s_setprio 1
    v_mfma_f32_16x16x32_bf16 v[134:137], v[214:217], v[194:197], v[134:137]
    ds_read_b64_tr_b16 v[114:115], v3 offset:4608
    v_mfma_f32_16x16x32_bf16 v[138:141], v[218:221], v[194:197], v[138:141]
    ds_read_b64_tr_b16 v[116:117], v3 offset:4752
    buffer_load_dwordx4 v11, s[24:27], s58 offen offset:3072 lds
    v_mfma_f32_16x16x32_bf16 v[142:145], v[222:225], v[194:197], v[142:145]
    ds_read_b128 v[102:105], v2 offset:2560
    v_mfma_f32_16x16x32_bf16 v[158:161], v[222:225], v[198:201], v[158:161]
    ds_read_b64_tr_b16 v[118:119], v3 offset:4640
    v_mfma_f32_16x16x32_bf16 v[154:157], v[218:221], v[198:201], v[154:157]
    ds_read_b64_tr_b16 v[120:121], v3 offset:4784
    v_mfma_f32_16x16x32_bf16 v[150:153], v[214:217], v[198:201], v[150:153]
    ds_read_b128 v[106:109], v2 offset:4608
    s_add_u32 m0, s54, s70
    s_mul_i32 s59, s52, s56
    buffer_load_dwordx4 v12, s[28:31], s59 offen lds
    v_mfma_f32_16x16x32_bf16 v[146:149], v[210:213], v[198:201], v[146:149]
    ds_read_b64_tr_b16 v[122:123], v3 offset:4720
    v_mfma_f32_16x16x32_bf16 v[162:165], v[210:213], v[202:205], v[162:165]
    ds_read_b64_tr_b16 v[124:125], v3 offset:4864
    v_mfma_f32_16x16x32_bf16 v[166:169], v[214:217], v[202:205], v[166:169]
    ds_read_b128 v[110:113], v2 offset:6656
    v_mfma_f32_16x16x32_bf16 v[170:173], v[218:221], v[202:205], v[170:173]
    ds_read_b64_tr_b16 v[126:127], v4 offset:4608
    buffer_load_dwordx4 v13, s[28:31], s59 offen offset:1024 lds
    v_mfma_f32_16x16x32_bf16 v[174:177], v[222:225], v[202:205], v[174:177]
    ds_read_b64_tr_b16 v[128:129], v4 offset:4752
    v_mfma_f32_16x16x32_bf16 v[190:193], v[222:225], v[206:209], v[190:193]
    v_add_u32 v2, s68, v2
    v_add_u32 v3, s68, v3
    v_mfma_f32_16x16x32_bf16 v[186:189], v[218:221], v[206:209], v[186:189]
    s_add_u32 s52, s52, 1
    s_cmp_eq_u32 s52, 10
    s_cselect_b32 s52, 0, s52
    s_add_u32 s54, s54, 50176
    s_cmp_eq_u32 s54, 150528
    s_cselect_b32 s54, 0, s54
    v_add_u32 v4, s68, v4
    v_mfma_f32_16x16x32_bf16 v[182:185], v[214:217], v[206:209], v[182:185]
    s_sub_u32 s53, s53, 1
    s_cmp_gt_u32 s53, 2
    v_mfma_f32_16x16x32_bf16 v[178:181], v[210:213], v[206:209], v[178:181]
    s_cbranch_scc1 L_P1a
    s_waitcnt vmcnt(6) lgkmcnt(0)
    s_barrier
    buffer_load_dwordx4 v[36:39], v82, s[36:39], 0 offen offset:0 sc1
    buffer_load_dwordx4 v[40:43], v82, s[36:39], 0 offen offset:1024 sc1
    buffer_load_dwordx4 v[44:47], v82, s[36:39], 0 offen offset:2048 sc1
    buffer_load_dwordx4 v[48:51], v82, s[36:39], 0 offen offset:3072 sc1
    buffer_load_dwordx2 v[52:53], v83, s[36:39], 0 offen offset:0 sc1
    buffer_load_dwordx2 v[54:55], v83, s[36:39], 0 offen offset:512 sc1
    buffer_load_dwordx2 v[56:57], v83, s[36:39], 0 offen offset:1024 sc1
    buffer_load_dwordx2 v[58:59], v83, s[36:39], 0 offen offset:1536 sc1
    buffer_load_dwordx2 v[60:61], v83, s[36:39], 0 offen offset:2048 sc1
    s_branch L_P1a_tin
L_P1a_t:
    s_waitcnt vmcnt(9) lgkmcnt(0)
    s_barrier
L_P1a_tin:
    v_mfma_f32_16x16x32_bf16 v[130:133], v[114:117], v[98:101], v[130:133]
    ds_read_b128 v[194:197], v2 offset:0
    s_setprio 1
    v_mfma_f32_16x16x32_bf16 v[134:137], v[118:121], v[98:101], v[134:137]
    ds_read_b64_tr_b16 v[210:211], v3 offset:0
    v_mfma_f32_16x16x32_bf16 v[138:141], v[122:125], v[98:101], v[138:141]
    ds_read_b64_tr_b16 v[212:213], v3 offset:144
    v_mfma_f32_16x16x32_bf16 v[142:145], v[126:129], v[98:101], v[142:145]
    ds_read_b128 v[198:201], v2 offset:2048
    v_mfma_f32_16x16x32_bf16 v[158:161], v[126:129], v[102:105], v[158:161]
    ds_read_b64_tr_b16 v[214:215], v3 offset:32
    v_mfma_f32_16x16x32_bf16 v[154:157], v[122:125], v[102:105], v[154:157]
    ds_read_b64_tr_b16 v[216:217], v3 offset:176
    v_mfma_f32_16x16x32_bf16 v[150:153], v[118:121], v[102:105], v[150:153]
    ds_read_b128 v[202:205], v2 offset:4096
    s_add_u32 s61, s67, 50176
    s_cmp_eq_u32 s61, 150528
    s_cselect_b32 s61, 0, s61
    s_sub_u32 s68, s61, s67
    s_mov_b32 s67, s61
    v_mfma_f32_16x16x32_bf16 v[146:149], v[114:117], v[102:105], v[146:149]
    ds_read_b64_tr_b16 v[218:219], v3 offset:112
    v_mfma_f32_16x16x32_bf16 v[162:165], v[114:117], v[106:109], v[162:165]
    ds_read_b64_tr_b16 v[220:221], v3 offset:256
    v_mfma_f32_16x16x32_bf16 v[166:169], v[118:121], v[106:109], v[166:169]
    ds_read_b128 v[206:209], v2 offset:6144
    v_mfma_f32_16x16x32_bf16 v[170:173], v[122:125], v[106:109], v[170:173]
    ds_read_b64_tr_b16 v[222:223], v4 offset:0
    v_mfma_f32_16x16x32_bf16 v[174:177], v[126:129], v[106:109], v[174:177]
    ds_read_b64_tr_b16 v[224:225], v4 offset:144
    v_mfma_f32_16x16x32_bf16 v[190:193], v[126:129], v[110:113], v[190:193]
    v_mfma_f32_16x16x32_bf16 v[186:189], v[122:125], v[110:113], v[186:189]
    v_mfma_f32_16x16x32_bf16 v[182:185], v[118:121], v[110:113], v[182:185]
    v_mfma_f32_16x16x32_bf16 v[178:181], v[114:117], v[110:113], v[178:181]
    s_waitcnt lgkmcnt(0)
    v_mfma_f32_16x16x32_bf16 v[130:133], v[210:213], v[194:197], v[130:133]
    ds_read_b128 v[98:101], v2 offset:512
    v_mfma_f32_16x16x32_bf16 v[134:137], v[214:217], v[194:197], v[134:137]
    ds_read_b64_tr_b16 v[114:115], v3 offset:4608
    v_mfma_f32_16x16x32_bf16 v[138:141], v[218:221], v[194:197], v[138:141]
    ds_read_b64_tr_b16 v[116:117], v3 offset:4752
    v_mfma_f32_16x16x32_bf16 v[142:145], v[222:225], v[194:197], v[142:145]
    ds_read_b128 v[102:105], v2 offset:2560
    v_mfma_f32_16x16x32_bf16 v[158:161], v[222:225], v[198:201], v[158:161]
    ds_read_b64_tr_b16 v[118:119], v3 offset:4640
    v_mfma_f32_16x16x32_bf16 v[154:157], v[218:221], v[198:201], v[154:157]
    ds_read_b64_tr_b16 v[120:121], v3 offset:4784
    v_mfma_f32_16x16x32_bf16 v[150:153], v[214:217], v[198:201], v[150:153]
    ds_read_b128 v[106:109], v2 offset:4608
    v_mfma_f32_16x16x32_bf16 v[146:149], v[210:213], v[198:201], v[146:149]
    ds_read_b64_tr_b16 v[122:123], v3 offset:4720
    v_mfma_f32_16x16x32_bf16 v[162:165], v[210:213], v[202:205], v[162:165]
    ds_read_b64_tr_b16 v[124:125], v3 offset:4864
    v_mfma_f32_16x16x32_bf16 v[166:169], v[214:217], v[202:205], v[166:169]
    ds_read_b128 v[110:113], v2 offset:6656
    v_mfma_f32_16x16x32_bf16 v[170:173], v[218:221], v[202:205], v[170:173]
    ds_read_b64_tr_b16 v[126:127], v4 offset:4608
    v_mfma_f32_16x16x32_bf16 v[174:177], v[222:225], v[202:205], v[174:177]
    ds_read_b64_tr_b16 v[128:129], v4 offset:4752
    v_mfma_f32_16x16x32_bf16 v[190:193], v[222:225], v[206:209], v[190:193]
    v_add_u32 v2, s68, v2
    v_add_u32 v3, s68, v3
    v_mfma_f32_16x16x32_bf16 v[186:189], v[218:221], v[206:209], v[186:189]
    v_add_u32 v4, s68, v4
    v_mfma_f32_16x16x32_bf16 v[182:185], v[214:217], v[206:209], v[182:185]
    s_sub_u32 s53, s53, 1
    s_cmp_lg_u32 s53, 0
    v_mfma_f32_16x16x32_bf16 v[178:181], v[210:213], v[206:209], v[178:181]
    s_cbranch_scc1 L_P1a_t
    s_waitcnt vmcnt(0)
    s_mov_b32 s83, 0x100000
L_P1a_chk:
    v_cmp_eq_u64 s[58:59], s[64:65], v[38:39]
    v_cmp_eq_u64 vcc, s[64:65], v[42:43]
    v_add_f32 v244, v52, v54
    v_add_f32 v245, v56, v58
    s_and_b64 s[58:59], s[58:59], vcc
    v_cmp_eq_u64 s[60:61], s[64:65], v[46:47]
    v_cmp_eq_u64 vcc, s[64:65], v[50:51]
    s_nop 0
    s_and_b64 s[58:59], s[58:59], s[60:61]
    s_and_b64 s[58:59], s[58:59], vcc
    v_xor_b32 v246, v53, v55
    v_xor_b32 v247, v57, v59
    v_xor_b32 v248, v53, v61
    v_xor_b32 v249, v53, v57
    v_or3_b32 v246, v246, v247, v248
    v_xor_b32 v247, s64, v53
    v_or3_b32 v246, v246, v247, v249
    v_cmp_eq_u32 vcc, 0, v246
    v_add_f32 v244, v244, v60
    v_add_f32 v244, v244, v245
    s_and_b64 s[58:59], s[58:59], vcc
    s_cmp_eq_u64 s[58:59], -1
    s_cbranch_scc0 L_P1a_again
    s_waitcnt lgkmcnt(0)
    ds_write_b32 v64, v244
    ds_read_b128 v[194:197], v65 offset:0
    ds_read_b128 v[198:201], v65 offset:64
    ds_read_b128 v[202:205], v65 offset:128
    ds_read_b128 v[206:209], v65 offset:192
    v_mfma_f32_16x16x32_bf16 v[130:133], v[114:117], v[98:101], v[130:133]
    s_setprio 1
    v_mfma_f32_16x16x32_bf16 v[134:137], v[118:121], v[98:101], v[134:137]
    v_mfma_f32_16x16x32_bf16 v[138:141], v[122:125], v[98:101], v[138:141]
    v_mfma_f32_16x16x32_bf16 v[142:145], v[126:129], v[98:101], v[142:145]
    v_mfma_f32_16x16x32_bf16 v[158:161], v[126:129], v[102:105], v[158:161]
    v_mfma_f32_16x16x32_bf16 v[154:157], v[122:125], v[102:105], v[154:157]
    v_mfma_f32_16x16x32_bf16 v[150:153], v[118:121], v[102:105], v[150:153]
    v_mfma_f32_16x16x32_bf16 v[146:149], v[114:117], v[102:105], v[146:149]
    v_mfma_f32_16x16x32_bf16 v[162:165], v[114:117], v[106:109], v[162:165]
    v_mfma_f32_16x16x32_bf16 v[166:169], v[118:121], v[106:109], v[166:169]
    v_mfma_f32_16x16x32_bf16 v[170:173], v[122:125], v[106:109], v[170:173]
    v_mfma_f32_16x16x32_bf16 v[174:177], v[126:129], v[106:109], v[174:177]
    v_mfma_f32_16x16x32_bf16 v[190:193], v[126:129], v[110:113], v[190:193]
    v_mfma_f32_16x16x32_bf16 v[186:189], v[122:125], v[110:113], v[186:189]
    v_mfma_f32_16x16x32_bf16 v[182:185], v[118:121], v[110:113], v[182:185]
    v_mfma_f32_16x16x32_bf16 v[178:181], v[114:117], v[110:113], v[178:181]
    s_waitcnt lgkmcnt(0)
    s_mov_b32 s63, 1051011932
    s_add_u32 s58, s80, 4096
    s_mov_b32 s84, 1120403456
    v_mul_f32 v92, s63, v37
    s_nop 3
    v_pk_fma_f32 v[134:135], v[198:199], v[36:37], v[134:135] op_sel_hi:[1,0,1] neg_lo:[0,1,0] neg_hi:[0,1,0]
    v_pk_fma_f32 v[136:137], v[200:201], v[36:37], v[136:137] op_sel_hi:[1,0,1] neg_lo:[0,1,0] neg_hi:[0,1,0]
    v_pk_fma_f32 v[138:139], v[202:203], v[36:37], v[138:139] op_sel_hi:[1,0,1] neg_lo:[0,1,0] neg_hi:[0,1,0]
    v_pk_fma_f32 v[140:141], v[204:205], v[36:37], v[140:141] op_sel_hi:[1,0,1] neg_lo:[0,1,0] neg_hi:[0,1,0]
    v_pk_mul_f32 v[134:135], v[134:135], v[36:37] op_sel:[0,1] op_sel_hi:[1,1]
    v_pk_mul_f32 v[136:137], v[136:137], v[36:37] op_sel:[0,1] op_sel_hi:[1,1]
    v_pk_mul_f32 v[138:139], v[138:139], v[36:37] op_sel:[0,1] op_sel_hi:[1,1]
    v_pk_mul_f32 v[140:141], v[140:141], v[36:37] op_sel:[0,1] op_sel_hi:[1,1]
    v_cndmask_b32 v94, v37, v92, s[22:23]
    v_pk_fma_f32 v[130:131], v[194:195], v[36:37], v[130:131] op_sel_hi:[1,0,1] neg_lo:[0,1,0] neg_hi:[0,1,0]
    v_pk_fma_f32 v[132:133], v[196:197], v[36:37], v[132:133] op_sel_hi:[1,0,1] neg_lo:[0,1,0] neg_hi:[0,1,0]
    v_pk_mul_f32 v[130:131], v[130:131], v[92:93] op_sel_hi:[1,0]
    v_pk_mul_f32 v[132:133], v[132:133], v[92:93] op_sel_hi:[1,0]
    v_pk_fma_f32 v[142:143], v[206:207], v[36:37], v[142:143] op_sel_hi:[1,0,1] neg_lo:[0,1,0] neg_hi:[0,1,0]
    v_pk_fma_f32 v[144:145], v[208:209], v[36:37], v[144:145] op_sel_hi:[1,0,1] neg_lo:[0,1,0] neg_hi:[0,1,0]
    v_pk_mul_f32 v[142:143], v[142:143], v[94:95] op_sel_hi:[1,0]
    v_pk_mul_f32 v[144:145], v[144:145], v[94:95] op_sel_hi:[1,0]
    v_cvt_pk_bf16_f32 v138, v138, v139
    v_cvt_pk_bf16_f32 v139, v140, v141
    ds_write_b64 v68, v[138:139] offset:0
    v_cvt_pk_bf16_f32 v142, v142, v143
    v_cvt_pk_bf16_f32 v143, v144, v145
    v_cvt_pk_bf16_f32 v102, v134, v135
    v_cvt_pk_bf16_f32 v103, v136, v137
    v_cvt_pk_bf16_f32 v130, v130, v131
    v_cvt_pk_bf16_f32 v131, v132, v133
    v_mul_f32 v92, s63, v41
    v_pk_fma_f32 v[150:151], v[198:199], v[40:41], v[150:151] op_sel_hi:[1,0,1] neg_lo:[0,1,0] neg_hi:[0,1,0]
    v_pk_fma_f32 v[152:153], v[200:201], v[40:41], v[152:153] op_sel_hi:[1,0,1] neg_lo:[0,1,0] neg_hi:[0,1,0]
    v_pk_fma_f32 v[154:155], v[202:203], v[40:41], v[154:155] op_sel_hi:[1,0,1] neg_lo:[0,1,0] neg_hi:[0,1,0]
    v_pk_fma_f32 v[156:157], v[204:205], v[40:41], v[156:157] op_sel_hi:[1,0,1] neg_lo:[0,1,0] neg_hi:[0,1,0]
    v_pk_mul_f32 v[150:151], v[150:151], v[40:41] op_sel:[0,1] op_sel_hi:[1,1]
    v_pk_mul_f32 v[152:153], v[152:153], v[40:41] op_sel:[0,1] op_sel_hi:[1,1]
    v_pk_mul_f32 v[154:155], v[154:155], v[40:41] op_sel:[0,1] op_sel_hi:[1,1]
    v_pk_mul_f32 v[156:157], v[156:157], v[40:41] op_sel:[0,1] op_sel_hi:[1,1]
    v_cndmask_b32 v94, v41, v92, s[22:23]
    v_pk_fma_f32 v[146:147], v[194:195], v[40:41], v[146:147] op_sel_hi:[1,0,1] neg_lo:[0,1,0] neg_hi:[0,1,0]
    v_pk_fma_f32 v[148:149], v[196:197], v[40:41], v[148:149] op_sel_hi:[1,0,1] neg_lo:[0,1,0] neg_hi:[0,1,0]
    v_pk_mul_f32 v[146:147], v[146:147], v[92:93] op_sel_hi:[1,0]
    v_pk_mul_f32 v[148:149], v[148:149], v[92:93] op_sel_hi:[1,0]
    v_pk_fma_f32 v[158:159], v[206:207], v[40:41], v[158:159] op_sel_hi:[1,0,1] neg_lo:[0,1,0] neg_hi:[0,1,0]
    v_pk_fma_f32 v[160:161], v[208:209], v[40:41], v[160:161] op_sel_hi:[1,0,1] neg_lo:[0,1,0] neg_hi:[0,1,0]
    v_pk_mul_f32 v[158:159], v[158:159], v[94:95] op_sel_hi:[1,0]
    v_pk_mul_f32 v[160:161], v[160:161], v[94:95] op_sel_hi:[1,0]
    v_cvt_pk_bf16_f32 v154, v154, v155
    v_cvt_pk_bf16_f32 v155, v156, v157
    ds_write_b64 v68, v[154:155] offset:640
    v_cvt_pk_bf16_f32 v144, v158, v159
    v_cvt_pk_bf16_f32 v145, v160, v161
    v_cvt_pk_bf16_f32 v104, v150, v151
    v_cvt_pk_bf16_f32 v105, v152, v153
    v_cvt_pk_bf16_f32 v132, v146, v147
    v_cvt_pk_bf16_f32 v133, v148, v149
    v_permlane16_swap_b32 v142, v144
    v_permlane16_swap_b32 v143, v145
    v_permlane16_swap_b32 v102, v104
    v_permlane16_swap_b32 v103, v105
    v_permlane16_swap_b32 v130, v132
    v_permlane16_swap_b32 v131, v133
    s_not_b64 exec, s[72:73]
    ds_write_b64 v66, v[142:143] offset:32
    v_mov_b32 v114, 0x3f803f80
    v_mov_b32 v115, 0x3f80
    v_mov_b32 v142, 0
    v_mov_b32 v143, 0
    s_mov_b64 exec, s[72:73]
    v_mov_b32 v114, v144
    v_mov_b32 v115, v145
    s_mov_b64 exec, -1
    ds_read_b64_tr_b16 v[106:107], v71 offset:0
    ds_read_b64_tr_b16 v[108:109], v71 offset:160
    ds_read_b64_tr_b16 v[110:111], v71 offset:640
    ds_read_b64_tr_b16 v[112:113], v71 offset:800
    buffer_store_dwordx4 v[102:105], v226, s[36:39], s80 offen sc1
    buffer_store_dwordx2 v[114:115], v70, s[36:39], s80 offen sc1
    v_mul_f32 v92, s63, v45
    v_pk_fma_f32 v[166:167], v[198:199], v[44:45], v[166:167] op_sel_hi:[1,0,1] neg_lo:[0,1,0] neg_hi:[0,1,0]
    v_pk_fma_f32 v[168:169], v[200:201], v[44:45], v[168:169] op_sel_hi:[1,0,1] neg_lo:[0,1,0] neg_hi:[0,1,0]
    v_pk_fma_f32 v[170:171], v[202:203], v[44:45], v[170:171] op_sel_hi:[1,0,1] neg_lo:[0,1,0] neg_hi:[0,1,0]
    v_pk_fma_f32 v[172:173], v[204:205], v[44:45], v[172:173] op_sel_hi:[1,0,1] neg_lo:[0,1,0] neg_hi:[0,1,0]
    v_pk_mul_f32 v[166:167], v[166:167], v[44:45] op_sel:[0,1] op_sel_hi:[1,1]
    v_pk_mul_f32 v[168:169], v[168:169], v[44:45] op_sel:[0,1] op_sel_hi:[1,1]
    v_pk_mul_f32 v[170:171], v[170:171], v[44:45] op_sel:[0,1] op_sel_hi:[1,1]
    v_pk_mul_f32 v[172:173], v[172:173], v[44:45] op_sel:[0,1] op_sel_hi:[1,1]
    v_cndmask_b32 v94, v45, v92, s[22:23]
    v_pk_fma_f32 v[162:163], v[194:195], v[44:45], v[162:163] op_sel_hi:[1,0,1] neg_lo:[0,1,0] neg_hi:[0,1,0]
    v_pk_fma_f32 v[164:165], v[196:197], v[44:45], v[164:165] op_sel_hi:[1,0,1] neg_lo:[0,1,0] neg_hi:[0,1,0]
    v_pk_mul_f32 v[162:163], v[162:163], v[92:93] op_sel_hi:[1,0]
    v_pk_mul_f32 v[164:165], v[164:165], v[92:93] op_sel_hi:[1,0]
    v_pk_fma_f32 v[174:175], v[206:207], v[44:45], v[174:175] op_sel_hi:[1,0,1] neg_lo:[0,1,0] neg_hi:[0,1,0]
    v_pk_fma_f32 v[176:177], v[208:209], v[44:45], v[176:177] op_sel_hi:[1,0,1] neg_lo:[0,1,0] neg_hi:[0,1,0]
    v_pk_mul_f32 v[174:175], v[174:175], v[94:95] op_sel_hi:[1,0]
    v_pk_mul_f32 v[176:177], v[176:177], v[94:95] op_sel_hi:[1,0]
    v_cvt_pk_bf16_f32 v170, v170, v171
    v_cvt_pk_bf16_f32 v171, v172, v173
    ds_write_b64 v68, v[170:171] offset:1280
    v_cvt_pk_bf16_f32 v174, v174, v175
    v_cvt_pk_bf16_f32 v175, v176, v177
    v_cvt_pk_bf16_f32 v116, v166, v167
    v_cvt_pk_bf16_f32 v117, v168, v169
    v_cvt_pk_bf16_f32 v162, v162, v163
    v_cvt_pk_bf16_f32 v163, v164, v165
    v_mul_f32 v92, s63, v49
    v_pk_fma_f32 v[182:183], v[198:199], v[48:49], v[182:183] op_sel_hi:[1,0,1] neg_lo:[0,1,0] neg_hi:[0,1,0]
    v_pk_fma_f32 v[184:185], v[200:201], v[48:49], v[184:185] op_sel_hi:[1,0,1] neg_lo:[0,1,0] neg_hi:[0,1,0]
    v_pk_fma_f32 v[186:187], v[202:203], v[48:49], v[186:187] op_sel_hi:[1,0,1] neg_lo:[0,1,0] neg_hi:[0,1,0]
    v_pk_fma_f32 v[188:189], v[204:205], v[48:49], v[188:189] op_sel_hi:[1,0,1] neg_lo:[0,1,0] neg_hi:[0,1,0]
    v_pk_mul_f32 v[182:183], v[182:183], v[48:49] op_sel:[0,1] op_sel_hi:[1,1]
    v_pk_mul_f32 v[184:185], v[184:185], v[48:49] op_sel:[0,1] op_sel_hi:[1,1]
    v_pk_mul_f32 v[186:187], v[186:187], v[48:49] op_sel:[0,1] op_sel_hi:[1,1]
    v_pk_mul_f32 v[188:189], v[188:189], v[48:49] op_sel:[0,1] op_sel_hi:[1,1]
    v_cndmask_b32 v94, v49, v92, s[22:23]
    v_pk_fma_f32 v[178:179], v[194:195], v[48:49], v[178:179] op_sel_hi:[1,0,1] neg_lo:[0,1,0] neg_hi:[0,1,0]
    v_pk_fma_f32 v[180:181], v[196:197], v[48:49], v[180:181] op_sel_hi:[1,0,1] neg_lo:[0,1,0] neg_hi:[0,1,0]
    v_pk_mul_f32 v[178:179], v[178:179], v[92:93] op_sel_hi:[1,0]
    v_pk_mul_f32 v[180:181], v[180:181], v[92:93] op_sel_hi:[1,0]
    v_pk_fma_f32 v[190:191], v[206:207], v[48:49], v[190:191] op_sel_hi:[1,0,1] neg_lo:[0,1,0] neg_hi:[0,1,0]
    v_pk_fma_f32 v[192:193], v[208:209], v[48:49], v[192:193] op_sel_hi:[1,0,1] neg_lo:[0,1,0] neg_hi:[0,1,0]
    v_pk_mul_f32 v[190:191], v[190:191], v[94:95] op_sel_hi:[1,0]
    v_pk_mul_f32 v[192:193], v[192:193], v[94:95] op_sel_hi:[1,0]
    v_cvt_pk_bf16_f32 v186, v186, v187
    v_cvt_pk_bf16_f32 v187, v188, v189
    ds_write_b64 v68, v[186:187] offset:1920
    v_cvt_pk_bf16_f32 v176, v190, v191
    v_cvt_pk_bf16_f32 v177, v192, v193
    v_cvt_pk_bf16_f32 v118, v182, v183
    v_cvt_pk_bf16_f32 v119, v184, v185
    v_cvt_pk_bf16_f32 v164, v178, v179
    v_cvt_pk_bf16_f32 v165, v180, v181
    v_permlane16_swap_b32 v174, v176
    v_permlane16_swap_b32 v175, v177
    v_permlane16_swap_b32 v116, v118
    v_permlane16_swap_b32 v117, v119
    v_permlane16_swap_b32 v162, v164
    v_permlane16_swap_b32 v163, v165
    s_not_b64 exec, s[72:73]
    ds_write_b64 v66, v[174:175] offset:1312
    v_mov_b32 v128, 0x3f803f80
    v_mov_b32 v129, 0x3f80
    v_mov_b32 v174, 0
    v_mov_b32 v175, 0
    s_mov_b64 exec, s[72:73]
    v_mov_b32 v128, v176
    v_mov_b32 v129, v177
    s_mov_b64 exec, -1
    ds_read_b64_tr_b16 v[120:121], v71 offset:1280
    ds_read_b64_tr_b16 v[122:123], v71 offset:1440
    ds_read_b64_tr_b16 v[124:125], v71 offset:1920
    ds_read_b64_tr_b16 v[126:127], v71 offset:2080
    s_waitcnt lgkmcnt(0)
    v_mfma_f32_32x32x16_bf16 v[194:209], v[102:105], v[130:133], 0
    ds_write_b128 v72, v[130:133]
    v_cndmask_b32 v106, v73, v106, s[74:75]
    v_cndmask_b32 v107, v73, v107, s[74:75]
    v_cndmask_b32 v108, v73, v108, s[74:75]
    v_cndmask_b32 v109, v73, v109, s[74:75]
    v_mfma_f32_32x32x8_bf16 v[194:209], v[114:115], v[142:143], v[194:209]
    v_cndmask_b32 v110, v73, v110, s[74:75]
    v_cndmask_b32 v111, v73, v111, s[74:75]
    v_cndmask_b32 v112, v73, v112, s[74:75]
    v_cndmask_b32 v113, v73, v113, s[74:75]
    buffer_store_dwordx4 v[106:109], v69, s[36:39], s80 offen sc1
    v_mfma_f32_32x32x16_bf16 v[210:225], v[116:119], v[130:133], 0
    ds_write_b128 v72, v[162:165] offset:1024
    buffer_store_dwordx4 v[110:113], v69, s[36:39], s80 offen offset:768 sc1
    v_mfma_f32_32x32x8_bf16 v[210:225], v[128:129], v[142:143], v[210:225]
    v_cndmask_b32 v120, v73, v120, s[74:75]
    v_cndmask_b32 v121, v73, v121, s[74:75]
    v_cndmask_b32 v122, v73, v122, s[74:75]
    v_cndmask_b32 v123, v73, v123, s[74:75]
    v_cndmask_b32 v124, v73, v124, s[74:75]
    v_cndmask_b32 v125, v73, v125, s[74:75]
    v_mfma_f32_32x32x16_bf16 v[2:17], v[102:105], v[162:165], 0
    v_cndmask_b32 v126, v73, v126, s[74:75]
    v_cndmask_b32 v127, v73, v127, s[74:75]
    buffer_store_dwordx4 v[116:119], v226, s[36:39], s58 offen sc1
    v_mfma_f32_32x32x8_bf16 v[2:17], v[114:115], v[174:175], v[2:17]
    buffer_store_dwordx2 v[128:129], v70, s[36:39], s58 offen sc1
    v_max3_f32 v244, v194, v195, v196
    v_max3_f32 v244, v244, v197, v198
    v_max3_f32 v244, v244, v199, v200
    v_max3_f32 v244, v244, v201, v202
    v_mfma_f32_32x32x16_bf16 v[82:97], v[116:119], v[162:165], 0
    buffer_store_dwordx4 v[120:123], v69, s[36:39], s58 offen sc1
    v_max3_f32 v244, v244, v203, v204
    v_max3_f32 v244, v244, v205, v206
    v_max3_f32 v244, v244, v207, v208
    v_max_f32 v244, v244, v209
    v_mfma_f32_32x32x8_bf16 v[82:97], v[128:129], v[174:175], v[82:97]
    buffer_store_dwordx4 v[124:127], v69, s[36:39], s58 offen offset:768 sc1
    v_max3_f32 v245, v210, v211, v212
    v_max3_f32 v245, v245, v213, v214
    v_max3_f32 v245, v245, v215, v216
    v_max3_f32 v245, v245, v217, v218
    v_max3_f32 v245, v245, v219, v220
    v_max3_f32 v245, v245, v221, v222
    v_max3_f32 v245, v245, v223, v224
    v_max_f32 v245, v245, v225
    v_max3_f32 v246, v2, v3, v4
    v_max3_f32 v246, v246, v5, v6
    v_max3_f32 v246, v246, v7, v8
    v_max3_f32 v246, v246, v9, v10
    v_max3_f32 v246, v246, v11, v12
    v_max3_f32 v246, v246, v13, v14
    v_max3_f32 v246, v246, v15, v16
    v_max_f32 v246, v246, v17
    v_mfma_f32_32x32x8_bf16 v[18:33], v[252:253], v[252:253], 0
    v_mfma_f32_32x32x8_bf16 v[34:49], v[252:253], v[252:253], 0
    v_max3_f32 v247, v82, v83, v84
    v_max3_f32 v247, v247, v85, v86
    v_max3_f32 v247, v247, v87, v88
    v_max3_f32 v247, v247, v89, v90
    v_max3_f32 v247, v247, v91, v92
    v_max3_f32 v247, v247, v93, v94
    v_max3_f32 v247, v247, v95, v96
    v_max_f32 v247, v247, v97
    v_mfma_f32_32x32x8_bf16 v[2:17], v[252:253], v[252:253], 0
    v_mfma_f32_32x32x8_bf16 v[86:101], v[252:253], v[252:253], 0
    v_max_f32 v244, v244, v245
    v_max_f32 v246, v246, v247
    s_nop 1
    v_permlane32_swap_b32 v244, v246
    v_max_f32 v244, v244, v246
    v_sub_f32 v244, -v244, s84
    v_and_b32 v246, s66, v244
    v_sub_f32 v244, v244, v246
    v_and_b32 v247, s66, v244
    v_sub_f32 v244, v244, v247
    v_lshrrev_b32 v246, 16, v246
    v_or_b32 v248, v246, v247
    v_lshrrev_b32 v249, 16, v244
    v_mov_b32 v250, v248
    v_mov_b32 v251, v249
    v_mfma_f32_32x32x8_bf16 v[50:65], v[252:253], v[252:253], 0
    v_permlane32_swap_b32 v248, v250
    v_permlane32_swap_b32 v249, v251
    v_cndmask_b32 v142, v248, v142, s[72:73]
    v_cndmask_b32 v143, v249, v143, s[72:73]
    ds_write_b64 v67, v[142:143] offset:0
    v_cndmask_b32 v174, v250, v174, s[72:73]
    v_cndmask_b32 v175, v251, v175, s[72:73]
    ds_write_b64 v67, v[174:175] offset:512
    s_add_u32 s76, s76, 4
    s_mov_b64 exec, 1
    v_mov_b32 v244, 158720
    v_mov_b32 v245, 1
    ds_add_u32 v244, v245
    s_mov_b32 s83, 0x400000
SB_1:
    ds_read_b32 v245, v244
    s_sub_u32 s83, s83, 1
    s_cbranch_scc1 L_END
    s_waitcnt lgkmcnt(0)
    v_cmp_le_u32 vcc, s76, v245
    s_cbranch_vccz SB_1
    s_mov_b64 exec, -1
    ds_read_b128 v[130:133], v74
    ds_read_b64 v[134:135], v78
    ds_read_b128 v[136:139], v74 offset:1024
    ds_read_b64 v[140:141], v78 offset:512
    ds_read_b128 v[142:145], v75
    ds_read_b64 v[146:147], v79
    ds_read_b128 v[148:151], v75 offset:1024
    ds_read_b64 v[152:153], v79 offset:512
    ds_read_b128 v[154:157], v76
    ds_read_b64 v[158:159], v80
    ds_read_b128 v[160:163], v76 offset:1024
    ds_read_b64 v[164:165], v80 offset:512
    v_mov_b32 v82, 0
    v_mov_b32 v83, 0
    v_mov_b32 v84, 0
    v_mov_b32 v85, 0
    ds_read_b128 v[166:169], v77
    ds_read_b64 v[170:171], v81
    ds_read_b128 v[172:175], v77 offset:1024
    ds_read_b64 v[176:177], v81 offset:512
    s_waitcnt lgkmcnt(0)
    v_mfma_f32_32x32x8_bf16 v[66:81], v[252:253], v[252:253], 0
L_GO:
    s_add_u32 s81, s80, 4096
    s_mov_b32 s53, 5
    s_add_u32 s100, s100, 1
    s_mov_b32 s83, 0x400000
    v_mfma_f32_32x32x16_bf16 v[178:193], v[102:105], v[130:133], 0
    v_mfma_f32_32x32x8_bf16 v[178:193], v[114:115], v[134:135], v[178:193]
    v_mov_b32 v202, 0
    v_mov_b32 v203, 0
    v_mov_b32 v204, 0
    v_mov_b32 v205, 0
    v_mov_b32 v206, 0
    v_mov_b32 v207, 0
    v_mov_b32 v208, 0
    v_mov_b32 v209, 0
    v_mov_b32 v218, 0
    v_mov_b32 v219, 0
    v_mov_b32 v220, 0
    v_mov_b32 v221, 0
    v_mov_b32 v244, s64
    v_mov_b32 v245, s65
    v_mov_b32 v246, s64
    v_mov_b32 v247, s65
    v_lshlrev_b32 v248, 4, v1
    v_mov_b32 v224, s89
    v_exp_f32 v178, v178
    v_exp_f32 v179, v179
    v_smfmac_f32_32x32x32_bf16 v[86:101], v[218:221], v[202:209], v229
    s_add_u32 s81, s81, 4096
    v_exp_f32 v180, v180
    v_exp_f32 v181, v181
    v_exp_f32 v182, v182
    v_mfma_f32_32x32x8_bf16 v[194:209], v[114:115], v[140:141], 0
    v_exp_f32 v183, v183
    v_exp_f32 v184, v184
    v_exp_f32 v185, v185
    v_exp_f32 v186, v186
    v_mfma_f32_32x32x16_bf16 v[194:209], v[102:105], v[136:139], v[194:209]
    s_and_b32 s81, s81, 0xffff
    v_exp_f32 v187, v187
    v_exp_f32 v188, v188
    v_exp_f32 v189, v189
    v_exp_f32 v190, v190
    v_smfmac_f32_32x32x32_bf16 v[2:17], v[106:109], v[178:185], v229
    s_lshr_b32 s59, s81, 13
    v_exp_f32 v191, v191
    v_exp_f32 v192, v192
    v_exp_f32 v193, v193
    v_exp_f32 v194, v194
    v_exp_f32 v195, v195
    v_smfmac_f32_32x32x32_bf16 v[2:17], v[110:113], v[186:193], v229
    v_exp_f32 v196, v196
    v_exp_f32 v197, v197
    v_exp_f32 v198, v198
    v_mfma_f32_32x32x8_bf16 v[178:193], v[114:115], v[146:147], 0
    v_exp_f32 v199, v199
    v_exp_f32 v200, v200
    v_exp_f32 v201, v201
    v_exp_f32 v202, v202
    v_mfma_f32_32x32x16_bf16 v[178:193], v[102:105], v[142:145], v[178:193]
    v_exp_f32 v203, v203
    v_exp_f32 v204, v204
    v_exp_f32 v205, v205
    v_exp_f32 v206, v206
    v_smfmac_f32_32x32x32_bf16 v[14:29], v[106:109], v[194:201], v229
    s_waitcnt vmcnt(0)
    s_mov_b64 exec, 15
    buffer_store_dwordx4 v[244:247], v248, s[36:39], s85 offen sc1
    s_mov_b64 exec, -1
    v_exp_f32 v207, v207
    v_exp_f32 v208, v208
    v_exp_f32 v209, v209
    v_exp_f32 v178, v178
    v_exp_f32 v179, v179
    v_smfmac_f32_32x32x32_bf16 v[14:29], v[110:113], v[202:209], v229
    v_exp_f32 v180, v180
    v_exp_f32 v181, v181
    v_exp_f32 v182, v182
    v_mfma_f32_32x32x8_bf16 v[194:209], v[114:115], v[152:153], 0
    v_exp_f32 v183, v183
    v_exp_f32 v184, v184
    v_exp_f32 v185, v185
    v_exp_f32 v186, v186
    v_mfma_f32_32x32x16_bf16 v[194:209], v[102:105], v[148:151], v[194:209]
    v_exp_f32 v187, v187
    v_exp_f32 v188, v188
    v_exp_f32 v189, v189
    v_exp_f32 v190, v190
    v_smfmac_f32_32x32x32_bf16 v[26:41], v[106:109], v[178:185], v229
    v_exp_f32 v191, v191
    v_exp_f32 v192, v192
    v_exp_f32 v193, v193
    v_exp_f32 v194, v194
    v_exp_f32 v195, v195
    v_smfmac_f32_32x32x32_bf16 v[26:41], v[110:113], v[186:193], v229
    v_exp_f32 v196, v196
    v_exp_f32 v197, v197
    v_exp_f32 v198, v198
    v_mfma_f32_32x32x8_bf16 v[178:193], v[114:115], v[158:159], 0
    v_exp_f32 v199, v199
    v_exp_f32 v200, v200
    v_exp_f32 v201, v201
    v_exp_f32 v202, v202
    v_mfma_f32_32x32x16_bf16 v[178:193], v[102:105], v[154:157], v[178:193]
    v_exp_f32 v203, v203
    v_exp_f32 v204, v204
    v_exp_f32 v205, v205
    v_exp_f32 v206, v206
    v_smfmac_f32_32x32x32_bf16 v[38:53], v[106:109], v[194:201], v229
    buffer_load_dwordx2 v[232:233], v230, s[36:39], 0 offen sc1
    v_exp_f32 v207, v207
    v_exp_f32 v208, v208
    v_exp_f32 v209, v209
    v_exp_f32 v178, v178
    v_exp_f32 v179, v179
    v_smfmac_f32_32x32x32_bf16 v[38:53], v[110:113], v[202:209], v229
    v_exp_f32 v180, v180
    v_exp_f32 v181, v181
    v_exp_f32 v182, v182
    v_mfma_f32_32x32x8_bf16 v[194:209], v[114:115], v[164:165], 0
    v_exp_f32 v183, v183
    v_exp_f32 v184, v184
    v_exp_f32 v185, v185
    v_exp_f32 v186, v186
    v_mfma_f32_32x32x16_bf16 v[194:209], v[102:105], v[160:163], v[194:209]
    v_exp_f32 v187, v187
    v_exp_f32 v188, v188
    v_exp_f32 v189, v189
    v_exp_f32 v190, v190
    v_smfmac_f32_32x32x32_bf16 v[50:65], v[106:109], v[178:185], v229
    v_exp_f32 v191, v191
    v_exp_f32 v192, v192
    v_exp_f32 v193, v193
    v_exp_f32 v194, v194
    v_exp_f32 v195, v195
    v_smfmac_f32_32x32x32_bf16 v[50:65], v[110:113], v[186:193], v229
    v_exp_f32 v196, v196
    v_exp_f32 v197, v197
    v_exp_f32 v198, v198
    v_mfma_f32_32x32x8_bf16 v[178:193], v[114:115], v[170:171], 0
    v_exp_f32 v199, v199
    v_exp_f32 v200, v200
    v_exp_f32 v201, v201
    v_exp_f32 v202, v202
    v_mfma_f32_32x32x16_bf16 v[178:193], v[102:105], v[166:169], v[178:193]
    v_exp_f32 v203, v203
    v_exp_f32 v204, v204
    v_exp_f32 v205, v205
    v_exp_f32 v206, v206
    v_smfmac_f32_32x32x32_bf16 v[62:77], v[106:109], v[194:201], v229
    v_exp_f32 v207, v207
    v_exp_f32 v208, v208
    v_exp_f32 v209, v209
    v_exp_f32 v178, v178
    v_exp_f32 v179, v179
    v_smfmac_f32_32x32x32_bf16 v[62:77], v[110:113], v[202:209], v229
    v_exp_f32 v180, v180
    v_exp_f32 v181, v181
    v_exp_f32 v182, v182
    v_mfma_f32_32x32x8_bf16 v[194:209], v[114:115], v[176:177], 0
    v_exp_f32 v183, v183
    v_exp_f32 v184, v184
    v_exp_f32 v185, v185
    v_exp_f32 v186, v186
    v_mfma_f32_32x32x16_bf16 v[194:209], v[102:105], v[172:175], v[194:209]
    v_exp_f32 v187, v187
    v_exp_f32 v188, v188
    v_exp_f32 v189, v189
    v_exp_f32 v190, v190
    v_smfmac_f32_32x32x32_bf16 v[74:89], v[106:109], v[178:185], v229
    v_exp_f32 v191, v191
    v_exp_f32 v192, v192
    v_exp_f32 v193, v193
    v_exp_f32 v194, v194
    v_exp_f32 v195, v195
    v_smfmac_f32_32x32x32_bf16 v[74:89], v[110:113], v[186:193], v229
    s_waitcnt vmcnt(0)
    v_cmp_eq_u64 vcc, s[64:65], v[232:233]
    v_exp_f32 v196, v196
    v_exp_f32 v197, v197
    v_exp_f32 v198, v198
    v_mfma_f32_32x32x8_bf16 v[178:193], v[128:129], v[134:135], 0
    s_bitcmp1_b32 vcc_lo, s59
    s_cbranch_scc0 L_FIRST
L_FIRSTD:
    buffer_load_dwordx4 v[210:213], v226, s[36:39], s81 offen sc1
    buffer_load_dwordx2 v[222:223], v228, s[36:39], s81 offen sc1
    v_exp_f32 v199, v199
    v_exp_f32 v200, v200
    v_exp_f32 v201, v201
    v_exp_f32 v202, v202
    v_mfma_f32_32x32x16_bf16 v[178:193], v[116:119], v[130:133], v[178:193]
    buffer_load_dwordx4 v[214:217], v227, s[36:39], s81 offen sc1
    v_exp_f32 v203, v203
    v_exp_f32 v204, v204
    v_exp_f32 v205, v205
    v_exp_f32 v206, v206
    v_smfmac_f32_32x32x32_bf16 v[86:101], v[106:109], v[194:201], v229
    buffer_load_dwordx4 v[218:221], v227, s[36:39], s81 offen offset:768 sc1
    buffer_load_dwordx2 v[232:233], v230, s[36:39], 0 offen sc1
    v_exp_f32 v207, v207
    v_exp_f32 v208, v208
    v_exp_f32 v209, v209
    s_branch L_ATT1
.p2align 3
L_ATT:
    v_exp_f32 v178, v178
    v_exp_f32 v179, v179
    v_smfmac_f32_32x32x32_bf16 v[86:101], v[218:221], v[202:209], v229
    s_add_u32 s81, s81, 4096
    v_exp_f32 v180, v180
    v_exp_f32 v181, v181
    v_exp_f32 v182, v182
    v_mfma_f32_32x32x8_bf16 v[194:209], v[114:115], v[140:141], 0
    v_exp_f32 v183, v183
    v_exp_f32 v184, v184
    v_exp_f32 v185, v185
    v_exp_f32 v186, v186
    v_mfma_f32_32x32x16_bf16 v[194:209], v[102:105], v[136:139], v[194:209]
    s_and_b32 s81, s81, 0xffff
    v_exp_f32 v187, v187
    v_exp_f32 v188, v188
    v_exp_f32 v189, v189
    v_exp_f32 v190, v190
    v_smfmac_f32_32x32x32_bf16 v[2:17], v[106:109], v[178:185], v229
    v_exp_f32 v191, v191
    v_exp_f32 v192, v192
    v_exp_f32 v193, v193
    v_exp_f32 v194, v194
    v_exp_f32 v195, v195
    v_smfmac_f32_32x32x32_bf16 v[2:17], v[110:113], v[186:193], v229
    buffer_load_dwordx4 v[210:213], v226, s[36:39], s81 offen sc1
    v_exp_f32 v196, v196
    v_exp_f32 v197, v197
    v_exp_f32 v198, v198
    v_mfma_f32_32x32x8_bf16 v[178:193], v[114:115], v[146:147], 0
    v_exp_f32 v199, v199
    v_exp_f32 v200, v200
    v_exp_f32 v201, v201
    v_exp_f32 v202, v202
    v_mfma_f32_32x32x16_bf16 v[178:193], v[102:105], v[142:145], v[178:193]
    buffer_load_dwordx2 v[222:223], v228, s[36:39], s81 offen sc1
    v_exp_f32 v203, v203
    v_exp_f32 v204, v204
    v_exp_f32 v205, v205
    v_exp_f32 v206, v206
    v_smfmac_f32_32x32x32_bf16 v[14:29], v[106:109], v[194:201], v229
    buffer_load_dwordx4 v[214:217], v227, s[36:39], s81 offen sc1
    v_exp_f32 v207, v207
    v_exp_f32 v208, v208
    v_exp_f32 v209, v209
    v_exp_f32 v178, v178
    v_exp_f32 v179, v179
    v_smfmac_f32_32x32x32_bf16 v[14:29], v[110:113], v[202:209], v229
    buffer_load_dwordx4 v[218:221], v227, s[36:39], s81 offen offset:768 sc1
    v_exp_f32 v180, v180
    v_exp_f32 v181, v181
    v_exp_f32 v182, v182
    v_mfma_f32_32x32x8_bf16 v[194:209], v[114:115], v[152:153], 0
    v_exp_f32 v183, v183
    v_exp_f32 v184, v184
    v_exp_f32 v185, v185
    v_exp_f32 v186, v186
    v_mfma_f32_32x32x16_bf16 v[194:209], v[102:105], v[148:151], v[194:209]
    v_exp_f32 v187, v187
    v_exp_f32 v188, v188
    v_exp_f32 v189, v189
    v_exp_f32 v190, v190
    v_smfmac_f32_32x32x32_bf16 v[26:41], v[106:109], v[178:185], v229
    v_exp_f32 v191, v191
    v_exp_f32 v192, v192
    v_exp_f32 v193, v193
    v_exp_f32 v194, v194
    v_exp_f32 v195, v195
    v_smfmac_f32_32x32x32_bf16 v[26:41], v[110:113], v[186:193], v229
    v_exp_f32 v196, v196
    v_exp_f32 v197, v197
    v_exp_f32 v198, v198
    v_mfma_f32_32x32x8_bf16 v[178:193], v[114:115], v[158:159], 0
    v_exp_f32 v199, v199
    v_exp_f32 v200, v200
    v_exp_f32 v201, v201
    v_exp_f32 v202, v202
    v_mfma_f32_32x32x16_bf16 v[178:193], v[102:105], v[154:157], v[178:193]
    v_exp_f32 v203, v203
    v_exp_f32 v204, v204
    v_exp_f32 v205, v205
    v_exp_f32 v206, v206
    v_smfmac_f32_32x32x32_bf16 v[38:53], v[106:109], v[194:201], v229
    v_exp_f32 v207, v207
    v_exp_f32 v208, v208
    v_exp_f32 v209, v209
    v_exp_f32 v178, v178
    v_exp_f32 v179, v179
    v_smfmac_f32_32x32x32_bf16 v[38:53], v[110:113], v[202:209], v229
    v_exp_f32 v180, v180
    v_exp_f32 v181, v181
    v_exp_f32 v182, v182
    v_mfma_f32_32x32x8_bf16 v[194:209], v[114:115], v[164:165], 0
    v_exp_f32 v183, v183
    v_exp_f32 v184, v184
    v_exp_f32 v185, v185
    v_exp_f32 v186, v186
    v_mfma_f32_32x32x16_bf16 v[194:209], v[102:105], v[160:163], v[194:209]
    v_exp_f32 v187, v187
    v_exp_f32 v188, v188
    v_exp_f32 v189, v189
    v_exp_f32 v190, v190
    v_smfmac_f32_32x32x32_bf16 v[50:65], v[106:109], v[178:185], v229
    v_exp_f32 v191, v191
    v_exp_f32 v192, v192
    v_exp_f32 v193, v193
    v_exp_f32 v194, v194
    v_exp_f32 v195, v195
    v_smfmac_f32_32x32x32_bf16 v[50:65], v[110:113], v[186:193], v229
    v_exp_f32 v196, v196
    v_exp_f32 v197, v197
    v_exp_f32 v198, v198
    v_mfma_f32_32x32x8_bf16 v[178:193], v[114:115], v[170:171], 0
    v_exp_f32 v199, v199
    v_exp_f32 v200, v200
    v_exp_f32 v201, v201
    v_exp_f32 v202, v202
    v_mfma_f32_32x32x16_bf16 v[178:193], v[102:105], v[166:169], v[178:193]
    v_exp_f32 v203, v203
    v_exp_f32 v204, v204
    v_exp_f32 v205, v205
    v_exp_f32 v206, v206
    v_smfmac_f32_32x32x32_bf16 v[62:77], v[106:109], v[194:201], v229
    v_exp_f32 v207, v207
    v_exp_f32 v208, v208
    v_exp_f32 v209, v209
    v_exp_f32 v178, v178
    v_exp_f32 v179, v179
    v_smfmac_f32_32x32x32_bf16 v[62:77], v[110:113], v[202:209], v229
    v_exp_f32 v180, v180
    v_exp_f32 v181, v181
    v_exp_f32 v182, v182
    v_mfma_f32_32x32x8_bf16 v[194:209], v[114:115], v[176:177], 0
    v_exp_f32 v183, v183
    v_exp_f32 v184, v184
    v_exp_f32 v185, v185
    v_exp_f32 v186, v186
    v_mfma_f32_32x32x16_bf16 v[194:209], v[102:105], v[172:175], v[194:209]
    v_exp_f32 v187, v187
    v_exp_f32 v188, v188
    v_exp_f32 v189, v189
    v_exp_f32 v190, v190
    v_smfmac_f32_32x32x32_bf16 v[74:89], v[106:109], v[178:185], v229
    v_exp_f32 v191, v191
    v_exp_f32 v192, v192
    v_exp_f32 v193, v193
    v_exp_f32 v194, v194
    v_exp_f32 v195, v195
    v_smfmac_f32_32x32x32_bf16 v[74:89], v[110:113], v[186:193], v229
    s_waitcnt vmcnt(4)
    v_exp_f32 v196, v196
    v_exp_f32 v197, v197
    v_exp_f32 v198, v198
    v_mfma_f32_32x32x8_bf16 v[178:193], v[128:129], v[134:135], 0
    v_exp_f32 v199, v199
    v_exp_f32 v200, v200
    v_exp_f32 v201, v201
    v_exp_f32 v202, v202
    v_mfma_f32_32x32x16_bf16 v[178:193], v[116:119], v[130:133], v[178:193]
    v_exp_f32 v203, v203
    v_exp_f32 v204, v204
    v_exp_f32 v205, v205
    v_exp_f32 v206, v206
    v_smfmac_f32_32x32x32_bf16 v[86:101], v[106:109], v[194:201], v229
    v_exp_f32 v207, v207
    v_exp_f32 v208, v208
    v_exp_f32 v209, v209
L_ATT1:
    v_exp_f32 v178, v178
    v_exp_f32 v179, v179
    v_smfmac_f32_32x32x32_bf16 v[86:101], v[110:113], v[202:209], v229
    s_add_u32 s81, s81, 4096
    v_exp_f32 v180, v180
    v_exp_f32 v181, v181
    v_exp_f32 v182, v182
    v_mfma_f32_32x32x8_bf16 v[194:209], v[128:129], v[140:141], 0
    v_exp_f32 v183, v183
    v_exp_f32 v184, v184
    v_exp_f32 v185, v185
    v_exp_f32 v186, v186
    v_mfma_f32_32x32x16_bf16 v[194:209], v[116:119], v[136:139], v[194:209]
    s_and_b32 s81, s81, 0xffff
    v_exp_f32 v187, v187
    v_exp_f32 v188, v188
    v_exp_f32 v189, v189
    v_exp_f32 v190, v190
    v_smfmac_f32_32x32x32_bf16 v[2:17], v[120:123], v[178:185], v229
    v_exp_f32 v191, v191
    v_exp_f32 v192, v192
    v_exp_f32 v193, v193
    v_exp_f32 v194, v194
    v_exp_f32 v195, v195
    v_smfmac_f32_32x32x32_bf16 v[2:17], v[124:127], v[186:193], v229
    buffer_load_dwordx4 v[102:105], v226, s[36:39], s81 offen sc1
    v_exp_f32 v196, v196
    v_exp_f32 v197, v197
    v_exp_f32 v198, v198
    v_mfma_f32_32x32x8_bf16 v[178:193], v[128:129], v[146:147], 0
    v_exp_f32 v199, v199
    v_exp_f32 v200, v200
    v_exp_f32 v201, v201
    v_exp_f32 v202, v202
    v_mfma_f32_32x32x16_bf16 v[178:193], v[116:119], v[142:145], v[178:193]
    buffer_load_dwordx2 v[114:115], v228, s[36:39], s81 offen sc1
    v_exp_f32 v203, v203
    v_exp_f32 v204, v204
    v_exp_f32 v205, v205
    v_exp_f32 v206, v206
    v_smfmac_f32_32x32x32_bf16 v[14:29], v[120:123], v[194:201], v229
    buffer_load_dwordx4 v[106:109], v227, s[36:39], s81 offen sc1
    v_exp_f32 v207, v207
    v_exp_f32 v208, v208
    v_exp_f32 v209, v209
    v_exp_f32 v178, v178
    v_exp_f32 v179, v179
    v_smfmac_f32_32x32x32_bf16 v[14:29], v[124:127], v[202:209], v229
    buffer_load_dwordx4 v[110:113], v227, s[36:39], s81 offen offset:768 sc1
    v_exp_f32 v180, v180
    v_exp_f32 v181, v181
    v_exp_f32 v182, v182
    v_mfma_f32_32x32x8_bf16 v[194:209], v[128:129], v[152:153], 0
    v_exp_f32 v183, v183
    v_exp_f32 v184, v184
    v_exp_f32 v185, v185
    v_exp_f32 v186, v186
    v_mfma_f32_32x32x16_bf16 v[194:209], v[116:119], v[148:151], v[194:209]
    v_exp_f32 v187, v187
    v_exp_f32 v188, v188
    v_exp_f32 v189, v189
    v_exp_f32 v190, v190
    v_smfmac_f32_32x32x32_bf16 v[26:41], v[120:123], v[178:185], v229
    v_exp_f32 v191, v191
    v_exp_f32 v192, v192
    v_exp_f32 v193, v193
    v_exp_f32 v194, v194
    v_exp_f32 v195, v195
    v_smfmac_f32_32x32x32_bf16 v[26:41], v[124:127], v[186:193], v229
    v_exp_f32 v196, v196
    v_exp_f32 v197, v197
    v_exp_f32 v198, v198
    v_mfma_f32_32x32x8_bf16 v[178:193], v[128:129], v[158:159], 0
    v_exp_f32 v199, v199
    v_exp_f32 v200, v200
    v_exp_f32 v201, v201
    v_exp_f32 v202, v202
    v_mfma_f32_32x32x16_bf16 v[178:193], v[116:119], v[154:157], v[178:193]
    v_exp_f32 v203, v203
    v_exp_f32 v204, v204
    v_exp_f32 v205, v205
    v_exp_f32 v206, v206
    v_smfmac_f32_32x32x32_bf16 v[38:53], v[120:123], v[194:201], v229
    v_exp_f32 v207, v207
    v_exp_f32 v208, v208
    v_exp_f32 v209, v209
    v_exp_f32 v178, v178
    v_exp_f32 v179, v179
    v_smfmac_f32_32x32x32_bf16 v[38:53], v[124:127], v[202:209], v229
    v_exp_f32 v180, v180
    v_exp_f32 v181, v181
    v_exp_f32 v182, v182
    v_mfma_f32_32x32x8_bf16 v[194:209], v[128:129], v[164:165], 0
    v_exp_f32 v183, v183
    v_exp_f32 v184, v184
    v_exp_f32 v185, v185
    v_exp_f32 v186, v186
    v_mfma_f32_32x32x16_bf16 v[194:209], v[116:119], v[160:163], v[194:209]
    v_exp_f32 v187, v187
    v_exp_f32 v188, v188
    v_exp_f32 v189, v189
    v_exp_f32 v190, v190
    v_smfmac_f32_32x32x32_bf16 v[50:65], v[120:123], v[178:185], v229
    v_exp_f32 v191, v191
    v_exp_f32 v192, v192
    v_exp_f32 v193, v193
    v_exp_f32 v194, v194
    v_exp_f32 v195, v195
    v_smfmac_f32_32x32x32_bf16 v[50:65], v[124:127], v[186:193], v229
    v_exp_f32 v196, v196
    v_exp_f32 v197, v197
    v_exp_f32 v198, v198
    v_mfma_f32_32x32x8_bf16 v[178:193], v[128:129], v[170:171], 0
    v_exp_f32 v199, v199
    v_exp_f32 v200, v200
    v_exp_f32 v201, v201
    v_exp_f32 v202, v202
    v_mfma_f32_32x32x16_bf16 v[178:193], v[116:119], v[166:169], v[178:193]
    v_exp_f32 v203, v203
    v_exp_f32 v204, v204
    v_exp_f32 v205, v205
    v_exp_f32 v206, v206
    v_smfmac_f32_32x32x32_bf16 v[62:77], v[120:123], v[194:201], v229
    v_exp_f32 v207, v207
    v_exp_f32 v208, v208
    v_exp_f32 v209, v209
    v_exp_f32 v178, v178
    v_exp_f32 v179, v179
    v_smfmac_f32_32x32x32_bf16 v[62:77], v[124:127], v[202:209], v229
    v_exp_f32 v180, v180
    v_exp_f32 v181, v181
    v_exp_f32 v182, v182
    v_mfma_f32_32x32x8_bf16 v[194:209], v[128:129], v[176:177], 0
    v_exp_f32 v183, v183
    v_exp_f32 v184, v184
    v_exp_f32 v185, v185
    v_exp_f32 v186, v186
    v_mfma_f32_32x32x16_bf16 v[194:209], v[116:119], v[172:175], v[194:209]
    v_exp_f32 v187, v187
    v_exp_f32 v188, v188
    v_exp_f32 v189, v189
    v_exp_f32 v190, v190
    v_smfmac_f32_32x32x32_bf16 v[74:89], v[120:123], v[178:185], v229
    v_exp_f32 v191, v191
    v_exp_f32 v192, v192
    v_exp_f32 v193, v193
    v_exp_f32 v194, v194
    v_exp_f32 v195, v195
    v_smfmac_f32_32x32x32_bf16 v[74:89], v[124:127], v[186:193], v229
    s_waitcnt vmcnt(4)
    v_exp_f32 v196, v196
    v_exp_f32 v197, v197
    v_exp_f32 v198, v198
    v_mfma_f32_32x32x8_bf16 v[178:193], v[222:223], v[134:135], 0
    v_exp_f32 v199, v199
    v_exp_f32 v200, v200
    v_exp_f32 v201, v201
    v_exp_f32 v202, v202
    v_mfma_f32_32x32x16_bf16 v[178:193], v[210:213], v[130:133], v[178:193]
    v_exp_f32 v203, v203
    v_exp_f32 v204, v204
    v_exp_f32 v205, v205
    v_exp_f32 v206, v206
    v_smfmac_f32_32x32x32_bf16 v[86:101], v[120:123], v[194:201], v229
    v_exp_f32 v207, v207
    v_exp_f32 v208, v208
    v_exp_f32 v209, v209
    v_exp_f32 v178, v178
    v_exp_f32 v179, v179
    v_smfmac_f32_32x32x32_bf16 v[86:101], v[124:127], v[202:209], v229
    s_add_u32 s81, s81, 4096
    v_exp_f32 v180, v180
    v_exp_f32 v181, v181
    v_exp_f32 v182, v182
    v_mfma_f32_32x32x8_bf16 v[194:209], v[222:223], v[140:141], 0
    v_exp_f32 v183, v183
    v_exp_f32 v184, v184
    v_exp_f32 v185, v185
    v_exp_f32 v186, v186
    v_mfma_f32_32x32x16_bf16 v[194:209], v[210:213], v[136:139], v[194:209]
    s_and_b32 s81, s81, 0xffff
    s_cmp_eq_u32 s53, 5
    v_exp_f32 v187, v187
    v_exp_f32 v188, v188
    v_exp_f32 v189, v189
    v_exp_f32 v190, v190
    v_smfmac_f32_32x32x32_bf16 v[2:17], v[214:217], v[178:185], v229
    s_cbranch_scc1 L_ALL
L_ALLD:
    v_exp_f32 v191, v191
    v_exp_f32 v192, v192
    v_exp_f32 v193, v193
    v_exp_f32 v194, v194
    v_exp_f32 v195, v195
    v_smfmac_f32_32x32x32_bf16 v[2:17], v[218:221], v[186:193], v229
    buffer_load_dwordx4 v[116:119], v226, s[36:39], s81 offen sc1
    v_exp_f32 v196, v196
    v_exp_f32 v197, v197
    v_exp_f32 v198, v198
    v_mfma_f32_32x32x8_bf16 v[178:193], v[222:223], v[146:147], 0
    v_exp_f32 v199, v199
    v_exp_f32 v200, v200
    v_exp_f32 v201, v201
    v_exp_f32 v202, v202
    v_mfma_f32_32x32x16_bf16 v[178:193], v[210:213], v[142:145], v[178:193]
    buffer_load_dwordx2 v[128:129], v228, s[36:39], s81 offen sc1
    v_exp_f32 v203, v203
    v_exp_f32 v204, v204
    v_exp_f32 v205, v205
    v_exp_f32 v206, v206
    v_smfmac_f32_32x32x32_bf16 v[14:29], v[214:217], v[194:201], v229
    buffer_load_dwordx4 v[120:123], v227, s[36:39], s81 offen sc1
    v_exp_f32 v207, v207
    v_exp_f32 v208, v208
    v_exp_f32 v209, v209
    v_exp_f32 v178, v178
    v_exp_f32 v179, v179
    v_smfmac_f32_32x32x32_bf16 v[14:29], v[218:221], v[202:209], v229
    buffer_load_dwordx4 v[124:127], v227, s[36:39], s81 offen offset:768 sc1
    v_exp_f32 v180, v180
    v_exp_f32 v181, v181
    v_exp_f32 v182, v182
    v_mfma_f32_32x32x8_bf16 v[194:209], v[222:223], v[152:153], 0
    v_exp_f32 v183, v183
    v_exp_f32 v184, v184
    v_exp_f32 v185, v185
    v_exp_f32 v186, v186
    v_mfma_f32_32x32x16_bf16 v[194:209], v[210:213], v[148:151], v[194:209]
    v_exp_f32 v187, v187
    v_exp_f32 v188, v188
    v_exp_f32 v189, v189
    v_exp_f32 v190, v190
    v_smfmac_f32_32x32x32_bf16 v[26:41], v[214:217], v[178:185], v229
    v_exp_f32 v191, v191
    v_exp_f32 v192, v192
    v_exp_f32 v193, v193
    v_exp_f32 v194, v194
    v_exp_f32 v195, v195
    v_smfmac_f32_32x32x32_bf16 v[26:41], v[218:221], v[186:193], v229
    v_exp_f32 v196, v196
    v_exp_f32 v197, v197
    v_exp_f32 v198, v198
    v_mfma_f32_32x32x8_bf16 v[178:193], v[222:223], v[158:159], 0
    v_exp_f32 v199, v199
    v_exp_f32 v200, v200
    v_exp_f32 v201, v201
    v_exp_f32 v202, v202
    v_mfma_f32_32x32x16_bf16 v[178:193], v[210:213], v[154:157], v[178:193]
    v_exp_f32 v203, v203
    v_exp_f32 v204, v204
    v_exp_f32 v205, v205
    v_exp_f32 v206, v206
    v_smfmac_f32_32x32x32_bf16 v[38:53], v[214:217], v[194:201], v229
    v_exp_f32 v207, v207
    v_exp_f32 v208, v208
    v_exp_f32 v209, v209
    v_exp_f32 v178, v178
    v_exp_f32 v179, v179
    v_smfmac_f32_32x32x32_bf16 v[38:53], v[218:221], v[202:209], v229
    v_exp_f32 v180, v180
    v_exp_f32 v181, v181
    v_exp_f32 v182, v182
    v_mfma_f32_32x32x8_bf16 v[194:209], v[222:223], v[164:165], 0
    v_exp_f32 v183, v183
    v_exp_f32 v184, v184
    v_exp_f32 v185, v185
    v_exp_f32 v186, v186
    v_mfma_f32_32x32x16_bf16 v[194:209], v[210:213], v[160:163], v[194:209]
    v_exp_f32 v187, v187
    v_exp_f32 v188, v188
    v_exp_f32 v189, v189
    v_exp_f32 v190, v190
    v_smfmac_f32_32x32x32_bf16 v[50:65], v[214:217], v[178:185], v229
    v_exp_f32 v191, v191
    v_exp_f32 v192, v192
    v_exp_f32 v193, v193
    v_exp_f32 v194, v194
    v_exp_f32 v195, v195
    v_smfmac_f32_32x32x32_bf16 v[50:65], v[218:221], v[186:193], v229
    v_exp_f32 v196, v196
    v_exp_f32 v197, v197
    v_exp_f32 v198, v198
    v_mfma_f32_32x32x8_bf16 v[178:193], v[222:223], v[170:171], 0
    v_exp_f32 v199, v199
    v_exp_f32 v200, v200
    v_exp_f32 v201, v201
    v_exp_f32 v202, v202
    v_mfma_f32_32x32x16_bf16 v[178:193], v[210:213], v[166:169], v[178:193]
    v_exp_f32 v203, v203
    v_exp_f32 v204, v204
    v_exp_f32 v205, v205
    v_exp_f32 v206, v206
    v_smfmac_f32_32x32x32_bf16 v[62:77], v[214:217], v[194:201], v229
    v_exp_f32 v207, v207
    v_exp_f32 v208, v208
    v_exp_f32 v209, v209
    v_exp_f32 v178, v178
    v_exp_f32 v179, v179
    v_smfmac_f32_32x32x32_bf16 v[62:77], v[218:221], v[202:209], v229
    v_exp_f32 v180, v180
    v_exp_f32 v181, v181
    v_exp_f32 v182, v182
    v_mfma_f32_32x32x8_bf16 v[194:209], v[222:223], v[176:177], 0
    v_exp_f32 v183, v183
    v_exp_f32 v184, v184
    v_exp_f32 v185, v185
    v_exp_f32 v186, v186
    v_mfma_f32_32x32x16_bf16 v[194:209], v[210:213], v[172:175], v[194:209]
    v_exp_f32 v187, v187
    v_exp_f32 v188, v188
    v_exp_f32 v189, v189
    v_exp_f32 v190, v190
    v_smfmac_f32_32x32x32_bf16 v[74:89], v[214:217], v[178:185], v229
    v_exp_f32 v191, v191
    v_exp_f32 v192, v192
    v_exp_f32 v193, v193
    v_exp_f32 v194, v194
    v_exp_f32 v195, v195
    v_smfmac_f32_32x32x32_bf16 v[74:89], v[218:221], v[186:193], v229
    s_waitcnt vmcnt(4)
    v_exp_f32 v196, v196
    v_exp_f32 v197, v197
    v_exp_f32 v198, v198
    v_mfma_f32_32x32x8_bf16 v[178:193], v[114:115], v[134:135], 0
    v_exp_f32 v199, v199
    v_exp_f32 v200, v200
    v_exp_f32 v201, v201
    v_exp_f32 v202, v202
    v_mfma_f32_32x32x16_bf16 v[178:193], v[102:105], v[130:133], v[178:193]
    s_sub_u32 s53, s53, 1
    v_exp_f32 v203, v203
    v_exp_f32 v204, v204
    v_exp_f32 v205, v205
    v_exp_f32 v206, v206
    v_smfmac_f32_32x32x32_bf16 v[86:101], v[214:217], v[194:201], v229
    s_cmp_lg_u32 s53, 0
    v_exp_f32 v207, v207
    v_exp_f32 v208, v208
    v_exp_f32 v209, v209
    s_cbranch_scc1 L_ATT
    v_exp_f32 v178, v178
    v_exp_f32 v179, v179
    v_smfmac_f32_32x32x32_bf16 v[86:101], v[218:221], v[202:209], v229
    v_mov_b32 v247, 158720
    v_exp_f32 v180, v180
    v_exp_f32 v181, v181
    v_exp_f32 v182, v182
    v_mfma_f32_32x32x8_bf16 v[194:209], v[114:115], v[140:141], 0
    ds_read_b128 v[248:251], v247
    v_exp_f32 v183, v183
    v_exp_f32 v184, v184
    v_exp_f32 v185, v185
    v_exp_f32 v186, v186
    v_mfma_f32_32x32x16_bf16 v[194:209], v[102:105], v[136:139], v[194:209]
    v_exp_f32 v187, v187
    v_exp_f32 v188, v188
    v_exp_f32 v189, v189
    v_exp_f32 v190, v190
    v_smfmac_f32_32x32x32_bf16 v[2:17], v[106:109], v[178:185], v229
L_XFREE:
    s_waitcnt lgkmcnt(0)
    v_min_u32 v249, v249, v251
    v_cmp_le_u32 vcc, 4, v249
    s_cbranch_vccz L_XFW
    v_exp_f32 v191, v191
    v_exp_f32 v192, v192
    v_exp_f32 v193, v193
    v_exp_f32 v194, v194
    v_exp_f32 v195, v195
    v_smfmac_f32_32x32x32_bf16 v[2:17], v[110:113], v[186:193], v229
    v_exp_f32 v196, v196
    v_exp_f32 v197, v197
    v_exp_f32 v198, v198
    v_mfma_f32_32x32x8_bf16 v[178:193], v[114:115], v[146:147], 0
    v_exp_f32 v199, v199
    v_exp_f32 v200, v200
    v_exp_f32 v201, v201
    v_exp_f32 v202, v202
    v_mfma_f32_32x32x16_bf16 v[178:193], v[102:105], v[142:145], v[178:193]
    v_exp_f32 v203, v203
    v_exp_f32 v204, v204
    v_exp_f32 v205, v205
    v_exp_f32 v206, v206
    v_smfmac_f32_32x32x32_bf16 v[14:29], v[106:109], v[194:201], v229
    v_mov_b32 v225, s100
    v_xor_b32 v244, 16, v224
    v_xor_b32 v245, 8, v224
    v_exp_f32 v207, v207
    v_exp_f32 v208, v208
    v_exp_f32 v209, v209
    v_exp_f32 v178, v178
    v_exp_f32 v179, v179
    v_smfmac_f32_32x32x32_bf16 v[14:29], v[110:113], v[202:209], v229
    ds_write_b128 v234, v[2:5] offset:0
    v_exp_f32 v180, v180
    v_exp_f32 v181, v181
    v_exp_f32 v182, v182
    v_mfma_f32_32x32x8_bf16 v[194:209], v[114:115], v[152:153], 0
    v_exp_f32 v183, v183
    v_exp_f32 v184, v184
    v_exp_f32 v185, v185
    v_exp_f32 v186, v186
    v_mfma_f32_32x32x16_bf16 v[194:209], v[102:105], v[148:151], v[194:209]
    ds_write_b128 v234, v[6:9] offset:1024
    v_exp_f32 v187, v187
    v_exp_f32 v188, v188
    v_exp_f32 v189, v189
    v_exp_f32 v190, v190
    v_smfmac_f32_32x32x32_bf16 v[26:41], v[106:109], v[178:185], v229
    ds_write_b128 v234, v[10:13] offset:2048
    v_exp_f32 v191, v191
    v_exp_f32 v192, v192
    v_exp_f32 v193, v193
    v_exp_f32 v194, v194
    v_exp_f32 v195, v195
    v_smfmac_f32_32x32x32_bf16 v[26:41], v[110:113], v[186:193], v229
    ds_write_b128 v234, v[14:17] offset:3072
    v_exp_f32 v196, v196
    v_exp_f32 v197, v197
    v_exp_f32 v198, v198
    v_mfma_f32_32x32x8_bf16 v[178:193], v[114:115], v[158:159], 0
    v_exp_f32 v199, v199
    v_exp_f32 v200, v200
    v_exp_f32 v201, v201
    v_exp_f32 v202, v202
    v_mfma_f32_32x32x16_bf16 v[178:193], v[102:105], v[154:157], v[178:193]
    ds_write_b128 v234, v[18:21] offset:4096
    v_exp_f32 v203, v203
    v_exp_f32 v204, v204
    v_exp_f32 v205, v205
    v_exp_f32 v206, v206
    v_smfmac_f32_32x32x32_bf16 v[38:53], v[106:109], v[194:201], v229
    ds_write_b128 v234, v[22:25] offset:5120
    v_exp_f32 v207, v207
    v_exp_f32 v208, v208
    v_exp_f32 v209, v209
    v_exp_f32 v178, v178
    v_exp_f32 v179, v179
    v_smfmac_f32_32x32x32_bf16 v[38:53], v[110:113], v[202:209], v229
    ds_write_b128 v234, v[26:29] offset:6144
    v_exp_f32 v180, v180
    v_exp_f32 v181, v181
    v_exp_f32 v182, v182
    v_mfma_f32_32x32x8_bf16 v[194:209], v[114:115], v[164:165], 0
    v_exp_f32 v183, v183
    v_exp_f32 v184, v184
    v_exp_f32 v185, v185
    v_exp_f32 v186, v186
    v_mfma_f32_32x32x16_bf16 v[194:209], v[102:105], v[160:163], v[194:209]
    ds_write_b128 v234, v[30:33] offset:7168
    v_exp_f32 v187, v187
    v_exp_f32 v188, v188
    v_exp_f32 v189, v189
    v_exp_f32 v190, v190
    v_smfmac_f32_32x32x32_bf16 v[50:65], v[106:109], v[178:185], v229
    ds_write_b128 v234, v[34:37] offset:8192
    v_exp_f32 v191, v191
    v_exp_f32 v192, v192
    v_exp_f32 v193, v193
    v_exp_f32 v194, v194
    v_exp_f32 v195, v195
    v_smfmac_f32_32x32x32_bf16 v[50:65], v[110:113], v[186:193], v229
    ds_write_b128 v234, v[38:41] offset:9216
    v_exp_f32 v196, v196
    v_exp_f32 v197, v197
    v_exp_f32 v198, v198
    v_mfma_f32_32x32x8_bf16 v[178:193], v[114:115], v[170:171], 0
    ds_write_b128 v234, v[42:45] offset:10240
    v_exp_f32 v199, v199
    v_exp_f32 v200, v200
    v_exp_f32 v201, v201
    v_exp_f32 v202, v202
    v_mfma_f32_32x32x16_bf16 v[178:193], v[102:105], v[166:169], v[178:193]
    ds_write_b128 v234, v[46:49] offset:11264
    ds_write_b32 v224, v225
    v_exp_f32 v203, v203
    v_exp_f32 v204, v204
    v_exp_f32 v205, v205
    v_exp_f32 v206, v206
    v_smfmac_f32_32x32x32_bf16 v[62:77], v[106:109], v[194:201], v229
    ds_read_b32 v246, v244
    v_exp_f32 v207, v207
    v_exp_f32 v208, v208
    v_exp_f32 v209, v209
    v_exp_f32 v178, v178
    v_exp_f32 v179, v179
    v_smfmac_f32_32x32x32_bf16 v[62:77], v[110:113], v[202:209], v229
    s_waitcnt lgkmcnt(0)
    v_cmp_le_u32 vcc, s100, v246
    v_exp_f32 v180, v180
    s_cbranch_vccz L_X1W
L_X1OK:
    ds_read_b128 v[2:5], v235 offset:0
    ds_read_b128 v[6:9], v235 offset:1024
    v_exp_f32 v181, v181
    v_exp_f32 v182, v182
    v_mfma_f32_32x32x8_bf16 v[194:209], v[114:115], v[176:177], 0
    ds_read_b128 v[10:13], v235 offset:2048
    ds_read_b128 v[14:17], v235 offset:3072
    ds_read_b128 v[18:21], v235 offset:4096
    v_exp_f32 v183, v183
    v_exp_f32 v184, v184
    v_exp_f32 v185, v185
    v_exp_f32 v186, v186
    v_mfma_f32_32x32x16_bf16 v[194:209], v[102:105], v[172:175], v[194:209]
    ds_read_b128 v[22:25], v235 offset:5120
    ds_read_b128 v[26:29], v235 offset:6144
    ds_read_b128 v[30:33], v235 offset:7168
    ds_read_b128 v[34:37], v235 offset:8192
    v_exp_f32 v187, v187
    v_exp_f32 v188, v188
    v_exp_f32 v189, v189
    v_exp_f32 v190, v190
    v_smfmac_f32_32x32x32_bf16 v[74:89], v[106:109], v[178:185], v229
    ds_read_b128 v[38:41], v235 offset:9216
    ds_read_b128 v[42:45], v235 offset:10240
    ds_read_b128 v[46:49], v235 offset:11264
    v_exp_f32 v191, v191
    v_exp_f32 v192, v192
    v_exp_f32 v193, v193
    v_exp_f32 v194, v194
    s_waitcnt lgkmcnt(0)
    v_add_f32 v50, v50, v2
    v_add_f32 v51, v51, v3
    v_add_f32 v52, v52, v4
    v_add_f32 v53, v53, v5
    v_exp_f32 v195, v195
    v_smfmac_f32_32x32x32_bf16 v[74:89], v[110:113], v[186:193], v229
    ds_write_b128 v235, v[50:53] offset:0
    v_add_f32 v54, v54, v6
    v_add_f32 v55, v55, v7
    v_add_f32 v56, v56, v8
    v_add_f32 v57, v57, v9
    v_exp_f32 v196, v196
    v_exp_f32 v197, v197
    ds_write_b128 v235, v[54:57] offset:1024
    v_add_f32 v58, v58, v10
    v_add_f32 v59, v59, v11
    v_add_f32 v60, v60, v12
    v_add_f32 v61, v61, v13
    v_exp_f32 v198, v198
    v_exp_f32 v199, v199
    ds_write_b128 v235, v[58:61] offset:2048
    v_add_f32 v62, v62, v14
    v_add_f32 v63, v63, v15
    v_add_f32 v64, v64, v16
    v_add_f32 v65, v65, v17
    v_exp_f32 v200, v200
    ds_write_b128 v235, v[62:65] offset:3072
    v_add_f32 v66, v66, v18
    v_add_f32 v67, v67, v19
    v_add_f32 v68, v68, v20
    v_add_f32 v69, v69, v21
    v_exp_f32 v201, v201
    v_exp_f32 v202, v202
    ds_write_b128 v235, v[66:69] offset:4096
    v_add_f32 v70, v70, v22
    v_add_f32 v71, v71, v23
    v_add_f32 v72, v72, v24
    v_add_f32 v73, v73, v25
    v_exp_f32 v203, v203
    ds_write_b128 v235, v[70:73] offset:5120
    ds_write_b32 v224, v225 offset:4
    v_exp_f32 v204, v204
    v_exp_f32 v205, v205
    v_exp_f32 v206, v206
    v_smfmac_f32_32x32x32_bf16 v[86:101], v[106:109], v[194:201], v229
    ds_read_b32 v246, v245 offset:4
    v_exp_f32 v207, v207
    v_exp_f32 v208, v208
    v_exp_f32 v209, v209
    v_pk_add_f32 v[74:75], v[74:75], v[26:27]
    v_pk_add_f32 v[76:77], v[76:77], v[28:29]
    v_smfmac_f32_32x32x32_bf16 v[86:101], v[110:113], v[202:209], v229
    s_mov_b32 s83, 0x400000
L_X2:
    s_waitcnt lgkmcnt(0)
    v_cmp_le_u32 vcc, s100, v246
    s_cbranch_vccnz L_X2OK
    ds_read_b32 v246, v245 offset:4
    s_sub_u32 s83, s83, 1
    s_cbranch_scc1 L_END
    s_branch L_X2
L_X2OK:
    ds_read_b128 v[178:181], v236 offset:0
    ds_read_b128 v[182:185], v236 offset:1024
    ds_read_b128 v[186:189], v236 offset:2048
    ds_read_b128 v[190:193], v236 offset:3072
    ds_read_b128 v[194:197], v236 offset:4096
    ds_read_b128 v[198:201], v236 offset:5120
    v_pk_add_f32 v[78:79], v[78:79], v[30:31]
    v_pk_add_f32 v[80:81], v[80:81], v[32:33]
    v_pk_add_f32 v[82:83], v[82:83], v[34:35]
    v_pk_add_f32 v[84:85], v[84:85], v[36:37]
    v_pk_add_f32 v[86:87], v[86:87], v[38:39]
    v_pk_add_f32 v[88:89], v[88:89], v[40:41]
    v_pk_add_f32 v[90:91], v[90:91], v[42:43]
    v_pk_add_f32 v[92:93], v[92:93], v[44:45]
    v_pk_add_f32 v[94:95], v[94:95], v[46:47]
    v_pk_add_f32 v[96:97], v[96:97], v[48:49]
    s_add_u32 s61, s87, 40960
    s_add_u32 s62, s88, 40960
    s_cmp_eq_u32 s78, 0
    s_cbranch_scc0 L_PUBDONE
    s_waitcnt lgkmcnt(3)
    v_pk_add_f32 v[186:187], v[186:187], v[82:83]
    v_pk_add_f32 v[178:179], v[178:179], v[74:75]
    v_mov_b32 v244, v186
    v_mov_b32 v245, v186
    v_pk_add_f32 v[180:181], v[180:181], v[76:77]
    v_pk_add_f32 v[182:183], v[182:183], v[78:79]
    v_permlane32_swap_b32 v244, v245
    v_rcp_f32 v246, v245
    v_pk_add_f32 v[184:185], v[184:185], v[80:81]
    v_pk_add_f32 v[188:189], v[188:189], v[84:85]
    v_pk_mul_f32 v[178:179], v[178:179], v[246:247] op_sel_hi:[1,0]
    v_pk_mul_f32 v[180:181], v[180:181], v[246:247] op_sel_hi:[1,0]
    v_pk_mul_f32 v[182:183], v[182:183], v[246:247] op_sel_hi:[1,0]
    v_pk_mul_f32 v[184:185], v[184:185], v[246:247] op_sel_hi:[1,0]
    v_pk_mul_f32 v[186:187], v[186:187], v[246:247] op_sel_hi:[1,0]
    v_pk_mul_f32 v[188:189], v[188:189], v[246:247] op_sel_hi:[1,0]
    v_cvt_pk_bf16_f32 v2, v178, v179
    v_cvt_pk_bf16_f32 v3, v180, v181
    v_cvt_pk_bf16_f32 v4, v182, v183
    v_cvt_pk_bf16_f32 v5, v184, v185
    v_cvt_pk_bf16_f32 v6, v186, v187
    v_cvt_pk_bf16_f32 v7, v188, v189
    buffer_store_dwordx4 v[2:5], v242, s[36:39], s87 offen sc1
    buffer_store_dwordx2 v[6:7], v243, s[36:39], s88 offen sc1
    s_waitcnt lgkmcnt(0)
    v_pk_add_f32 v[198:199], v[198:199], v[94:95]
    v_pk_add_f32 v[190:191], v[190:191], v[86:87]
    v_mov_b32 v248, v198
    v_mov_b32 v249, v198
    v_pk_add_f32 v[192:193], v[192:193], v[88:89]
    v_pk_add_f32 v[194:195], v[194:195], v[90:91]
    v_permlane32_swap_b32 v248, v249
    v_rcp_f32 v250, v249
    v_pk_add_f32 v[196:197], v[196:197], v[92:93]
    v_pk_add_f32 v[200:201], v[200:201], v[96:97]
    v_pk_mul_f32 v[190:191], v[190:191], v[250:251] op_sel_hi:[1,0]
    v_pk_mul_f32 v[192:193], v[192:193], v[250:251] op_sel_hi:[1,0]
    v_pk_mul_f32 v[194:195], v[194:195], v[250:251] op_sel_hi:[1,0]
    v_pk_mul_f32 v[196:197], v[196:197], v[250:251] op_sel_hi:[1,0]
    v_pk_mul_f32 v[198:199], v[198:199], v[250:251] op_sel_hi:[1,0]
    v_pk_mul_f32 v[200:201], v[200:201], v[250:251] op_sel_hi:[1,0]
    v_cvt_pk_bf16_f32 v8, v190, v191
    v_cvt_pk_bf16_f32 v9, v192, v193
    v_cvt_pk_bf16_f32 v10, v194, v195
    v_cvt_pk_bf16_f32 v11, v196, v197
    v_cvt_pk_bf16_f32 v12, v198, v199
    v_cvt_pk_bf16_f32 v13, v200, v201
    buffer_store_dwordx4 v[8:11], v242, s[36:39], s61 offen sc1
    buffer_store_dwordx2 v[12:13], v243, s[36:39], s62 offen sc1
    v_mov_b32 v26, 0
    v_mov_b32 v27, 0
    v_pk_fma_f32 v[26:27], v[178:179], v[252:253], v[26:27]
    v_pk_fma_f32 v[26:27], v[180:181], v[252:253], v[26:27]
    v_pk_fma_f32 v[26:27], v[182:183], v[252:253], v[26:27]
    v_pk_fma_f32 v[26:27], v[184:185], v[252:253], v[26:27]
    v_pk_fma_f32 v[26:27], v[186:187], v[252:253], v[26:27]
    v_pk_fma_f32 v[26:27], v[188:189], v[252:253], v[26:27]
    v_pk_fma_f32 v[26:27], v[190:191], v[252:253], v[26:27]
    v_pk_fma_f32 v[26:27], v[192:193], v[252:253], v[26:27]
    v_pk_fma_f32 v[26:27], v[194:195], v[252:253], v[26:27]
    v_pk_fma_f32 v[26:27], v[196:197], v[252:253], v[26:27]
    v_pk_fma_f32 v[26:27], v[198:199], v[252:253], v[26:27]
    v_pk_fma_f32 v[26:27], v[200:201], v[252:253], v[26:27]
    v_max_f32 v244, v245, v249
    v_min_f32 v246, v245, v249
    v_add_f32 v26, v26, v27
    v_cmp_gt_f32 vcc, 2122317824, v244
    v_cmp_eq_f32 s[74:75], 0, v26
    s_nop 0
    s_and_b64 s[74:75], s[74:75], vcc
    v_cmp_lt_f32 vcc, 142606336, v246
    s_nop 1
    s_and_b64 s[74:75], s[74:75], vcc
    s_cmp_eq_u64 s[74:75], -1
    s_cselect_b32 s59, 1, s77
    s_cmp_eq_u32 s59, 0
    s_waitcnt vmcnt(0)
    s_cbranch_scc1 L_BAD
    s_mov_b64 exec, 15
    v_mov_b32 v244, s64
    v_mov_b32 v245, s65
    v_mov_b32 v246, s64
    v_mov_b32 v247, s65
    v_lshlrev_b32 v248, 4, v1
    buffer_store_dwordx4 v[244:247], v248, s[36:39], s86 offen sc1
    s_mov_b64 exec, -1
    s_mov_b32 s78, 1
    s_branch L_PUBDONE
L_BAD:
    v_mov_b32 v244, 158728
    v_mov_b32 v245, 1
    ds_write_b32 v244, v245
L_PUBDONE:
    s_mov_b64 exec, 1
    v_mov_b32 v244, 158736
    v_mov_b32 v245, 1
    ds_add_u32 v244, v245
    s_mov_b64 exec, -1
    s_setprio 0
    s_cmp_eq_u32 s77, 0
    s_cbranch_scc0 L_FIN
    s_add_u32 s76, s76, 4
    s_mov_b64 exec, 1
    v_mov_b32 v244, 158720
    v_mov_b32 v245, 1
    ds_add_u32 v244, v245
    s_mov_b32 s83, 0x400000
SB_3:
    ds_read_b32 v245, v244
    s_sub_u32 s83, s83, 1
    s_cbranch_scc1 L_END
    s_waitcnt lgkmcnt(0)
    v_cmp_le_u32 vcc, s76, v245
    s_cbranch_vccz SB_3
    s_mov_b64 exec, -1
    v_mov_b32 v244, 158728
    ds_read_b32 v245, v244
    s_waitcnt lgkmcnt(0)
    v_cmp_eq_u32 vcc, 0, v245
    s_cbranch_vccnz L_FIN
    s_mov_b32 s77, 1
    s_mov_b32 s84, 0
    s_mov_b32 s53, 0
    v_mfma_f32_32x32x8_bf16 v[2:17], v[252:253], v[252:253], 0
    v_mfma_f32_32x32x8_bf16 v[18:33], v[252:253], v[252:253], 0
    v_mfma_f32_32x32x8_bf16 v[34:49], v[252:253], v[252:253], 0
    v_mfma_f32_32x32x8_bf16 v[50:65], v[252:253], v[252:253], 0
    v_mfma_f32_32x32x8_bf16 v[66:81], v[252:253], v[252:253], 0
    v_mfma_f32_32x32x8_bf16 v[86:101], v[252:253], v[252:253], 0
    v_mov_b32 v82, 0
    v_mov_b32 v83, 0
    v_mov_b32 v84, 0
    v_mov_b32 v85, 0
    s_not_b64 exec, s[72:73]
    v_mov_b32 v134, 0
    v_mov_b32 v135, 0
    v_mov_b32 v140, 0
    v_mov_b32 v141, 0
    v_mov_b32 v146, 0
    v_mov_b32 v147, 0
    v_mov_b32 v152, 0
    v_mov_b32 v153, 0
    v_mov_b32 v158, 0
    v_mov_b32 v159, 0
    v_mov_b32 v164, 0
    v_mov_b32 v165, 0
    v_mov_b32 v170, 0
    v_mov_b32 v171, 0
    v_mov_b32 v176, 0
    v_mov_b32 v177, 0
    s_mov_b64 exec, -1
L_PRE:
    s_lshl_b32 s59, s53, 12
    buffer_load_dwordx4 v[102:105], v226, s[36:39], s59 offen sc1
    buffer_load_dwordx2 v[114:115], v228, s[36:39], s59 offen sc1
    s_waitcnt vmcnt(0)
    v_mfma_f32_32x32x16_bf16 v[178:193], v[102:105], v[130:133], 0
    v_mfma_f32_32x32x8_bf16 v[178:193], v[114:115], v[134:135], v[178:193]
    s_nop 11
    v_max3_f32 v244, v178, v179, v180
    v_max3_f32 v244, v244, v181, v182
    v_max3_f32 v244, v244, v183, v184
    v_max3_f32 v244, v244, v185, v186
    v_max3_f32 v244, v244, v187, v188
    v_max3_f32 v244, v244, v189, v190
    v_max3_f32 v244, v244, v191, v192
    v_max_f32 v246, v244, v193
    ds_max_f32 v238, v246 offset:0
    v_mfma_f32_32x32x16_bf16 v[178:193], v[102:105], v[136:139], 0
    v_mfma_f32_32x32x8_bf16 v[178:193], v[114:115], v[140:141], v[178:193]
    s_nop 11
    v_max3_f32 v244, v178, v179, v180
    v_max3_f32 v244, v244, v181, v182
    v_max3_f32 v244, v244, v183, v184
    v_max3_f32 v244, v244, v185, v186
    v_max3_f32 v244, v244, v187, v188
    v_max3_f32 v244, v244, v189, v190
    v_max3_f32 v244, v244, v191, v192
    v_max_f32 v247, v244, v193
    ds_max_f32 v238, v247 offset:128
    v_mfma_f32_32x32x16_bf16 v[178:193], v[102:105], v[142:145], 0
    v_mfma_f32_32x32x8_bf16 v[178:193], v[114:115], v[146:147], v[178:193]
    s_nop 11
    v_max3_f32 v244, v178, v179, v180
    v_max3_f32 v244, v244, v181, v182
    v_max3_f32 v244, v244, v183, v184
    v_max3_f32 v244, v244, v185, v186
    v_max3_f32 v244, v244, v187, v188
    v_max3_f32 v244, v244, v189, v190
    v_max3_f32 v244, v244, v191, v192
    v_max_f32 v246, v244, v193
    ds_max_f32 v239, v246 offset:0
    v_mfma_f32_32x32x16_bf16 v[178:193], v[102:105], v[148:151], 0
    v_mfma_f32_32x32x8_bf16 v[178:193], v[114:115], v[152:153], v[178:193]
    s_nop 11
    v_max3_f32 v244, v178, v179, v180
    v_max3_f32 v244, v244, v181, v182
    v_max3_f32 v244, v244, v183, v184
    v_max3_f32 v244, v244, v185, v186
    v_max3_f32 v244, v244, v187, v188
    v_max3_f32 v244, v244, v189, v190
    v_max3_f32 v244, v244, v191, v192
    v_max_f32 v247, v244, v193
    ds_max_f32 v239, v247 offset:128
    v_mfma_f32_32x32x16_bf16 v[178:193], v[102:105], v[154:157], 0
    v_mfma_f32_32x32x8_bf16 v[178:193], v[114:115], v[158:159], v[178:193]
    s_nop 11
    v_max3_f32 v244, v178, v179, v180
    v_max3_f32 v244, v244, v181, v182
    v_max3_f32 v244, v244, v183, v184
    v_max3_f32 v244, v244, v185, v186
    v_max3_f32 v244, v244, v187, v188
    v_max3_f32 v244, v244, v189, v190
    v_max3_f32 v244, v244, v191, v192
    v_max_f32 v246, v244, v193
    ds_max_f32 v240, v246 offset:0
    v_mfma_f32_32x32x16_bf16 v[178:193], v[102:105], v[160:163], 0
    v_mfma_f32_32x32x8_bf16 v[178:193], v[114:115], v[164:165], v[178:193]
    s_nop 11
    v_max3_f32 v244, v178, v179, v180
    v_max3_f32 v244, v244, v181, v182
    v_max3_f32 v244, v244, v183, v184
    v_max3_f32 v244, v244, v185, v186
    v_max3_f32 v244, v244, v187, v188
    v_max3_f32 v244, v244, v189, v190
    v_max3_f32 v244, v244, v191, v192
    v_max_f32 v247, v244, v193
    ds_max_f32 v240, v247 offset:128
    v_mfma_f32_32x32x16_bf16 v[178:193], v[102:105], v[166:169], 0
    v_mfma_f32_32x32x8_bf16 v[178:193], v[114:115], v[170:171], v[178:193]
    s_nop 11
    v_max3_f32 v244, v178, v179, v180
    v_max3_f32 v244, v244, v181, v182
    v_max3_f32 v244, v244, v183, v184
    v_max3_f32 v244, v244, v185, v186
    v_max3_f32 v244, v244, v187, v188
    v_max3_f32 v244, v244, v189, v190
    v_max3_f32 v244, v244, v191, v192
    v_max_f32 v246, v244, v193
    ds_max_f32 v241, v246 offset:0
    v_mfma_f32_32x32x16_bf16 v[178:193], v[102:105], v[172:175], 0
    v_mfma_f32_32x32x8_bf16 v[178:193], v[114:115], v[176:177], v[178:193]
    s_nop 11
    v_max3_f32 v244, v178, v179, v180
    v_max3_f32 v244, v244, v181, v182
    v_max3_f32 v244, v244, v183, v184
    v_max3_f32 v244, v244, v185, v186
    v_max3_f32 v244, v244, v187, v188
    v_max3_f32 v244, v244, v189, v190
    v_max3_f32 v244, v244, v191, v192
    v_max_f32 v247, v244, v193
    ds_max_f32 v241, v247 offset:128
    s_add_u32 s53, s53, 1
    s_cmp_eq_u32 s53, 16
    s_cbranch_scc0 L_PRE
    s_add_u32 s59, s80, 4096
    buffer_load_dwordx4 v[102:105], v226, s[36:39], s80 offen sc1
    buffer_load_dwordx2 v[114:115], v228, s[36:39], s80 offen sc1
    buffer_load_dwordx4 v[106:109], v227, s[36:39], s80 offen sc1
    buffer_load_dwordx4 v[110:113], v227, s[36:39], s80 offen offset:768 sc1
    buffer_load_dwordx4 v[116:119], v226, s[36:39], s59 offen sc1
    buffer_load_dwordx2 v[128:129], v228, s[36:39], s59 offen sc1
    buffer_load_dwordx4 v[120:123], v227, s[36:39], s59 offen sc1
    buffer_load_dwordx4 v[124:127], v227, s[36:39], s59 offen offset:768 sc1
    s_add_u32 s76, s76, 4
    s_mov_b64 exec, 1
    v_mov_b32 v244, 158720
    v_mov_b32 v245, 1
    ds_add_u32 v244, v245
    s_mov_b32 s83, 0x400000
SB_5:
    ds_read_b32 v245, v244
    s_sub_u32 s83, s83, 1
    s_cbranch_scc1 L_END
    s_waitcnt lgkmcnt(0)
    v_cmp_le_u32 vcc, s76, v245
    s_cbranch_vccz SB_5
    s_mov_b64 exec, -1
    ds_read_b32 v178, v238 offset:0
    ds_read_b32 v179, v238 offset:128
    ds_read_b32 v180, v239 offset:0
    ds_read_b32 v181, v239 offset:128
    ds_read_b32 v182, v240 offset:0
    ds_read_b32 v183, v240 offset:128
    ds_read_b32 v184, v241 offset:0
    ds_read_b32 v185, v241 offset:128
    s_waitcnt vmcnt(0) lgkmcnt(0)
    s_not_b64 exec, s[72:73]
    v_sub_f32 v178, -v178, s84
    v_and_b32 v244, s66, v178
    v_sub_f32 v178, v178, v244
    v_and_b32 v245, s66, v178
    v_sub_f32 v178, v178, v245
    v_lshrrev_b32 v244, 16, v244
    v_or_b32 v134, v244, v245
    v_lshrrev_b32 v135, 16, v178
    v_sub_f32 v179, -v179, s84
    v_and_b32 v244, s66, v179
    v_sub_f32 v179, v179, v244
    v_and_b32 v245, s66, v179
    v_sub_f32 v179, v179, v245
    v_lshrrev_b32 v244, 16, v244
    v_or_b32 v140, v244, v245
    v_lshrrev_b32 v141, 16, v179
    v_sub_f32 v180, -v180, s84
    v_and_b32 v244, s66, v180
    v_sub_f32 v180, v180, v244
    v_and_b32 v245, s66, v180
    v_sub_f32 v180, v180, v245
    v_lshrrev_b32 v244, 16, v244
    v_or_b32 v146, v244, v245
    v_lshrrev_b32 v147, 16, v180
    v_sub_f32 v181, -v181, s84
    v_and_b32 v244, s66, v181
    v_sub_f32 v181, v181, v244
    v_and_b32 v245, s66, v181
    v_sub_f32 v181, v181, v245
    v_lshrrev_b32 v244, 16, v244
    v_or_b32 v152, v244, v245
    v_lshrrev_b32 v153, 16, v181
    v_sub_f32 v182, -v182, s84
    v_and_b32 v244, s66, v182
    v_sub_f32 v182, v182, v244
    v_and_b32 v245, s66, v182
    v_sub_f32 v182, v182, v245
    v_lshrrev_b32 v244, 16, v244
    v_or_b32 v158, v244, v245
    v_lshrrev_b32 v159, 16, v182
    v_sub_f32 v183, -v183, s84
    v_and_b32 v244, s66, v183
    v_sub_f32 v183, v183, v244
    v_and_b32 v245, s66, v183
    v_sub_f32 v183, v183, v245
    v_lshrrev_b32 v244, 16, v244
    v_or_b32 v164, v244, v245
    v_lshrrev_b32 v165, 16, v183
    v_sub_f32 v184, -v184, s84
    v_and_b32 v244, s66, v184
    v_sub_f32 v184, v184, v244
    v_and_b32 v245, s66, v184
    v_sub_f32 v184, v184, v245
    v_lshrrev_b32 v244, 16, v244
    v_or_b32 v170, v244, v245
    v_lshrrev_b32 v171, 16, v184
    v_sub_f32 v185, -v185, s84
    v_and_b32 v244, s66, v185
    v_sub_f32 v185, v185, v244
    v_and_b32 v245, s66, v185
    v_sub_f32 v185, v185, v245
    v_lshrrev_b32 v244, 16, v244
    v_or_b32 v176, v244, v245
    v_lshrrev_b32 v177, 16, v185
    s_mov_b64 exec, -1
    s_branch L_GO
L_FIRST:
    s_lshl_b32 s60, 1, s59
    s_mov_b32 s83, 0x100000
PL_7:
    buffer_load_dwordx2 v[232:233], v230, s[36:39], 0 offen sc1
    s_sub_u32 s83, s83, 1
    s_cbranch_scc1 L_END
    s_waitcnt vmcnt(0)
    v_cmp_eq_u64 vcc, s[64:65], v[232:233]
    s_nop 1
    s_and_b32 s58, vcc_lo, s60
    s_cmp_eq_u32 s58, s60
    s_cbranch_scc0 PL_7
    s_mov_b32 s83, 0x400000
    s_branch L_FIRSTD
L_ALL:
    v_cmp_eq_u64 vcc, s[64:65], v[232:233]
    s_lshl_b32 s59, 1, s50
    s_andn2_b32 s60, 0xff, s59
    s_and_b32 s58, vcc_lo, s60
    s_cmp_eq_u32 s58, s60
    s_cbranch_scc1 L_ALLG
    s_mov_b32 s83, 0x100000
PL_9:
    buffer_load_dwordx2 v[232:233], v230, s[36:39], 0 offen sc1
    s_sub_u32 s83, s83, 1
    s_cbranch_scc1 L_END
    s_waitcnt vmcnt(0)
    v_cmp_eq_u64 vcc, s[64:65], v[232:233]
    s_nop 1
    s_and_b32 s58, vcc_lo, s60
    s_cmp_eq_u32 s58, s60
    s_cbranch_scc0 PL_9
    s_mov_b32 s83, 0x400000
L_ALLG:
    s_mov_b64 exec, 1
    v_mov_b32 v244, 158732
    v_mov_b32 v245, 1
    ds_add_u32 v244, v245
    s_mov_b64 exec, -1
    s_branch L_ALLD
L_XFW:
    ds_read_b128 v[248:251], v247
    s_sub_u32 s83, s83, 1
    s_cbranch_scc1 L_END
    s_branch L_XFREE
L_X1W:
    s_mov_b32 s83, 0x400000
L_X1L:
    ds_read_b32 v246, v244
    s_sub_u32 s83, s83, 1
    s_cbranch_scc1 L_END
    s_waitcnt lgkmcnt(0)
    v_cmp_le_u32 vcc, s100, v246
    s_cbranch_vccz L_X1L
    s_branch L_X1OK
L_B:
    v_lshlrev_b32 v226, 4, v1
    s_lshl_b32 s59, s50, 2
    s_add_u32 s59, s59, s51
    s_mul_i32 s60, s59, 221184
    s_lshl_b32 s61, s62, 11
    s_add_u32 s60, s60, s61
    s_add_u32 s60, s60, 8388608
    s_bitcmp1_b32 3992452599, s49
    s_cselect_b32 s87, s60, 2147483648
    s_lshl_b32 s59, s59, 11
    s_lshl_b32 s61, s49, 6
    s_add_u32 s59, s59, s61
    s_add_u32 s85, s59, 18939904
    s_lshr_b32 s62, s49, 3
    s_and_b32 s63, s49, 7
    v_lshlrev_b32 v244, 4, v1
    s_add_u32 s58, s51, 1
    s_and_b32 s58, s58, 3
    s_mul_i32 s59, s58, 55296
    v_add_u32 v228, s59, v244
    s_mul_i32 s98, s58, 20480
    s_add_u32 s58, s51, 2
    s_and_b32 s58, s58, 3
    s_mul_i32 s59, s58, 55296
    v_add_u32 v229, s59, v244
    s_mul_i32 s99, s58, 20480
    s_add_u32 s58, s51, 3
    s_and_b32 s58, s58, 3
    s_mul_i32 s59, s58, 55296
    v_add_u32 v230, s59, v244
    s_mul_i32 s100, s58, 20480
    s_add_u32 s58, s51, 4
    s_and_b32 s58, s58, 3
    s_mul_i32 s59, s58, 55296
    v_add_u32 v231, s59, v244
    s_mul_i32 s101, s58, 20480
    v_add_u32 v244, 0, v1
    v_mul_u32_u24 v245, 6554, v244
    v_lshrrev_b32 v245, 16, v245
    v_mul_u32_u24 v245, 1120, v245
    v_lshl_add_u32 v232, v244, 4, v245
    v_add_u32 v244, 64, v1
    v_mul_u32_u24 v245, 6554, v244
    v_lshrrev_b32 v245, 16, v245
    v_mul_u32_u24 v245, 1120, v245
    v_lshl_add_u32 v233, v244, 4, v245
    v_subrev_u32 v233, 1024, v233
    v_add_u32 v244, 128, v1
    v_mul_u32_u24 v245, 6554, v244
    v_lshrrev_b32 v245, 16, v245
    v_mul_u32_u24 v245, 1120, v245
    v_lshl_add_u32 v234, v244, 4, v245
    v_subrev_u32 v234, 2048, v234
    v_add_u32 v244, 192, v1
    v_mul_u32_u24 v245, 6554, v244
    v_lshrrev_b32 v245, 16, v245
    v_mul_u32_u24 v245, 1120, v245
    v_lshl_add_u32 v235, v244, 4, v245
    v_subrev_u32 v235, 3072, v235
    v_add_u32 v244, 256, v1
    v_mul_u32_u24 v245, 6554, v244
    v_lshrrev_b32 v245, 16, v245
    v_mul_u32_u24 v245, 1120, v245
    v_lshl_add_u32 v236, v244, 4, v245
    v_bfe_u32 v244, v1, 2, 2
    v_mul_u32_u24 v244, 160, v244
    v_and_b32 v245, 3, v1
    v_lshl_add_u32 v244, v245, 3, v244
    s_mul_i32 s89, s51, 25600
    v_add_u32 v244, s89, v244
    v_lshrrev_b32 v245, 4, v1
    v_mul_u32_u24 v246, 3200, v245
    v_add_u32 v246, 2560, v246
    v_add_u32 v243, v246, v244
    v_and_b32 v246, 1, v245
    v_mul_u32_u24 v246, 640, v246
    v_add_u32 v244, v246, v244
    v_lshrrev_b32 v245, 5, v1
    v_mul_u32_u24 v246, 1280, v245
    v_add_u32 v237, v246, v244
    v_mul_u32_u24 v246, 3200, v245
    v_add_u32 v242, v246, v244
    s_mul_i32 s58, s51, 14
    s_cmp_eq_u32 s51, 3
    s_cselect_b32 s58, 41, s58
    s_cmp_ge_u32 s51, 2
    s_cselect_b32 s80, 13, 14
    s_mul_i32 s59, s63, 160
    s_mul_i32 s81, s58, 40960
    s_add_u32 s81, s81, s59
    s_mul_i32 s82, s51, 204800
    s_add_u32 s82, s82, s59
    s_lshl_b32 s60, s50, 2
    s_add_u32 s60, s60, s62
    s_mul_i32 s79, s60, 221184
    s_lshl_b32 s58, s58, 10
    s_add_u32 s79, s79, s58
    s_add_u32 s79, s79, 8388608
    s_mul_i32 s58, s60, 81920
    s_add_u32 s58, s58, 15728640
    s_add_u32 s98, s98, s58
    s_add_u32 s99, s99, s58
    s_add_u32 s100, s100, s58
    s_add_u32 s101, s101, s58
    s_mov_b32 s88, 247
    s_cmp_eq_u32 s51, 1
    s_cselect_b32 s88, 64768, s88
    s_cmp_eq_u32 s51, 2
    s_cselect_b32 s88, 28770304, s88
    s_cmp_eq_u32 s51, 3
    s_cselect_b32 s88, 3980394496, s88
    s_lshl_b32 s58, s60, 2
    s_add_u32 s58, s58, s51
    s_mul_i32 s58, s58, 20480
    s_add_u32 s58, s58, s59
    v_and_b32 v244, 15, v1
    v_mul_u32_u24 v244, 1280, v244
    v_lshrrev_b32 v245, 4, v1
    v_lshl_add_u32 v244, v245, 3, v244
    v_add_u32 v252, s58, v244
    s_lshl_b32 s58, s60, 11
    s_add_u32 s58, s58, 18939904
    v_and_b32 v253, 31, v1
    v_lshl_add_u32 v253, v253, 6, s58
    s_mov_b32 s66, 0xffff0000
    s_mov_b32 s67, 0
    s_mov_b32 s53, 10
    s_mov_b32 s76, 0
    v_cmp_gt_u32 s[72:73], 32, v1
    v_lshlrev_b32 v244, 2, v0
    v_mov_b32 v246, 0xff800000
    v_cmp_gt_u32 vcc, 1024, v244
    v_min_u32 v245, 1276, v244
    v_add_u32 v245, 157696, v245
    v_cndmask_b32 v246, 0, v246, vcc
    ds_write_b32 v245, v246
    v_mov_b32 v96, 0
    v_mov_b32 v97, 0
    v_mov_b32 v62, 0x3f803f80
    v_mov_b32 v63, 0x3f803f80
    v_mfma_f32_32x32x8_bf16 v[130:145], v[96:97], v[96:97], 0
    v_mfma_f32_32x32x8_bf16 v[146:161], v[96:97], v[96:97], 0
    v_mfma_f32_32x32x8_bf16 v[162:177], v[96:97], v[96:97], 0
    v_mfma_f32_32x32x8_bf16 v[178:193], v[96:97], v[96:97], 0
    v_mfma_f32_32x32x8_bf16 v[98:113], v[96:97], v[96:97], 0
    v_mfma_f32_32x32x8_bf16 v[114:129], v[96:97], v[96:97], 0
    v_mfma_f32_32x32x8_bf16 v[20:35], v[96:97], v[96:97], 0
    v_and_b32 v244, 15, v1
    v_lshrrev_b32 v245, 4, v1
    v_bfe_u32 v246, v1, 3, 1
    v_lshlrev_b32 v247, 1, v246
    v_xor_b32 v247, v247, v245
    v_lshlrev_b32 v247, 4, v247
    v_lshl_add_u32 v247, v246, 10, v247
    v_and_b32 v246, 7, v1
    v_lshl_add_u32 v247, v246, 6, v247
    s_lshl_b32 s58, s51, 13
    v_add_u32 v2, s58, v247
    s_lshl_b32 s58, s48, 8
    s_add_u32 s58, s58, 126976
    v_lshl_add_u32 v64, v1, 2, s58
    v_lshl_add_u32 v65, v245, 4, s58
    s_lshl_b32 s58, s50, 2
    s_add_u32 s58, s58, s51
    s_lshl_b32 s58, s58, 12
    s_add_u32 s58, s58, 19136512
    v_lshl_add_u32 v82, v244, 6, s58
    s_mul_i32 s58, s49, 5120
    s_add_u32 s58, s58, 19270144
    v_lshl_add_u32 v83, v1, 3, s58
    v_bfe_u32 v246, v1, 2, 2
    v_and_b32 v247, 3, v1
    v_lshl_add_u32 v248, v245, 3, v246
    v_lshlrev_b32 v248, 7, v248
    v_lshl_add_u32 v248, v247, 3, v248
    v_bfe_u32 v247, v1, 3, 2
    v_lshl_add_u32 v248, v247, 5, v248
    v_add_u32 v3, 41984, v248
    v_xor_b32 v4, 32, v3
    v_xor_b32 v5, 64, v3
    v_xor_b32 v6, 96, v3
    s_lshl_b32 s58, s2, 2
    s_add_u32 s58, s58, s51
    s_cmp_lt_u32 s58, 720
    s_cselect_b32 s44, s14, s8
    s_cselect_b32 s45, s15, s9
    s_mov_b32 s46, 819200
    s_cselect_b32 s46, 2211840, s46
    s_mov_b32 s47, 0x20000
    s_cselect_b32 s59, 0, 720
    s_sub_u32 s58, s58, s59
    s_mul_i32 s62, s58, 3072
    v_cmp_gt_u32 vcc, 24, v1
    v_lshlrev_b32 v244, 7, v1
    v_mov_b32 v245, 2147483648
    v_cndmask_b32 v18, v245, v244, vcc
    s_waitcnt vmcnt(7)
    v_readfirstlane_b32 s64, v15
    v_mov_b32 v244, 0
    v_mov_b32 v245, 0
    v_dot2_f32_bf16 v244, v84, v62, v244
    v_dot2_f32_bf16 v245, v84, v84, v245
    v_dot2_f32_bf16 v244, v85, v62, v244
    v_dot2_f32_bf16 v245, v85, v85, v245
    v_dot2_f32_bf16 v244, v86, v62, v244
    v_dot2_f32_bf16 v245, v86, v86, v245
    v_dot2_f32_bf16 v244, v87, v62, v244
    v_dot2_f32_bf16 v245, v87, v87, v245
    v_dot2_f32_bf16 v244, v88, v62, v244
    v_dot2_f32_bf16 v245, v88, v88, v245
    v_dot2_f32_bf16 v244, v89, v62, v244
    v_dot2_f32_bf16 v245, v89, v89, v245
    v_dot2_f32_bf16 v244, v90, v62, v244
    v_dot2_f32_bf16 v245, v90, v90, v245
    v_dot2_f32_bf16 v244, v91, v62, v244
    v_dot2_f32_bf16 v245, v91, v91, v245
    s_add_u32 s64, s64, 1
    s_not_b32 s65, s64
    s_nop 1
    v_add_f32_dpp v244, v244, v244 row_shr:1 bound_ctrl:0
    v_add_f32_dpp v245, v245, v245 row_shr:1 bound_ctrl:0
    s_nop 0
    v_add_f32_dpp v244, v244, v244 row_shr:2 bound_ctrl:0
    v_add_f32_dpp v245, v245, v245 row_shr:2 bound_ctrl:0
    s_nop 0
    v_add_f32_dpp v244, v244, v244 row_shr:4 bound_ctrl:0
    v_add_f32_dpp v245, v245, v245 row_shr:4 bound_ctrl:0
    s_nop 0
    v_add_f32_dpp v244, v244, v244 row_shr:8 bound_ctrl:0
    v_add_f32_dpp v245, v245, v245 row_shr:8 bound_ctrl:0
    s_nop 0
    v_add_f32_dpp v244, v244, v244 row_bcast:15 row_mask:0xa
    v_add_f32_dpp v245, v245, v245 row_bcast:15 row_mask:0xa
    s_nop 0
    v_add_f32_dpp v244, v244, v244 row_bcast:31 row_mask:0xc
    v_add_f32_dpp v245, v245, v245 row_bcast:31 row_mask:0xc
    s_nop 0
    s_mov_b32 s58, 986500301
    v_mul_f32 v244, s58, v244
    v_mul_f32 v245, s58, v245
    v_fma_f32 v245, -v244, v244, v245
    v_max_f32 v245, 0, v245
    v_add_f32 v245, 925353388, v245
    v_rsq_f32 v245, v245
    v_readlane_b32 s58, v244, 63
    s_add_u32 s84, s84, 19136512
    v_readlane_b32 s59, v245, 63
    s_mov_b64 exec, 15
    v_mov_b32 v246, s64
    v_mov_b32 v247, s65
    v_lshlrev_b32 v248, 4, v1
    v_mov_b32 v244, s58
    v_mov_b32 v245, s59
    buffer_store_dwordx4 v[244:247], v248, s[36:39], s84 offen sc1
    s_mov_b64 exec, -1
    s_lshl_b32 s58, s52, 7
    s_add_u32 m0, s54, s69
    s_add_u32 s58, s58, s55
    buffer_load_dwordx4 v8, s[24:27], s58 offen offset:0 lds
    buffer_load_dwordx4 v9, s[24:27], s58 offen offset:1024 lds
    buffer_load_dwordx4 v10, s[24:27], s58 offen offset:2048 lds
    buffer_load_dwordx4 v11, s[24:27], s58 offen offset:3072 lds
    s_add_u32 m0, s54, s70
    s_mul_i32 s59, s52, s56
    buffer_load_dwordx4 v12, s[28:31], s59 offen lds
    buffer_load_dwordx4 v13, s[28:31], s59 offen offset:1024 lds
    s_add_u32 m0, s54, s71
    s_mul_i32 s59, s52, 245760
    s_mov_b64 exec, 0xffff
    buffer_load_dwordx4 v14, s[32:35], s59 offen lds
    s_mov_b64 exec, -1
    s_add_u32 s52, s52, 1
    s_cmp_eq_u32 s52, 10
    s_cselect_b32 s52, 0, s52
    s_add_u32 s54, s54, 50176
    s_cmp_eq_u32 s54, 150528
    s_cselect_b32 s54, 0, s54
    s_cmp_lt_u32 s50, 5
    s_cselect_b32 s58, s51, 7
    s_waitcnt vmcnt(8) lgkmcnt(0)
    s_barrier
    s_cmp_eq_u32 s58, 1
    s_cbranch_scc0 L_P1b_in
    s_branch L_P1b_hin
L_P1b_h:
    s_waitcnt vmcnt(7) lgkmcnt(0)
    s_barrier
L_P1b_hin:
    v_mfma_f32_16x16x32_bf16 v[130:133], v[114:117], v[98:101], v[130:133]
    ds_read_b128 v[194:197], v2 offset:0
    s_setprio 1
    v_mfma_f32_16x16x32_bf16 v[134:137], v[118:121], v[98:101], v[134:137]
    ds_read_b64_tr_b16 v[210:211], v3 offset:0
    v_mfma_f32_4x4x4_16b_bf16 v[20:23], v[62:63], v[114:115], v[20:23]
    v_mfma_f32_16x16x32_bf16 v[138:141], v[122:125], v[98:101], v[138:141]
    ds_read_b64_tr_b16 v[212:213], v3 offset:512
    v_mfma_f32_16x16x32_bf16 v[142:145], v[126:129], v[98:101], v[142:145]
    ds_read_b128 v[198:201], v2 offset:2048
    v_mfma_f32_4x4x4_16b_bf16 v[24:27], v[62:63], v[118:119], v[24:27]
    v_mfma_f32_16x16x32_bf16 v[158:161], v[126:129], v[102:105], v[158:161]
    ds_read_b64_tr_b16 v[214:215], v4 offset:0
    s_lshl_b32 s58, s52, 7
    s_add_u32 m0, s54, s69
    s_add_u32 s58, s58, s55
    buffer_load_dwordx4 v8, s[24:27], s58 offen offset:0 lds
    v_mfma_f32_16x16x32_bf16 v[154:157], v[122:125], v[102:105], v[154:157]
    ds_read_b64_tr_b16 v[216:217], v4 offset:512
    v_mfma_f32_4x4x4_16b_bf16 v[28:31], v[62:63], v[122:123], v[28:31]
    v_mfma_f32_16x16x32_bf16 v[150:153], v[118:121], v[102:105], v[150:153]
    ds_read_b128 v[202:205], v2 offset:4096
    s_add_u32 s61, s67, 50176
    s_cmp_eq_u32 s61, 150528
    s_cselect_b32 s61, 0, s61
    s_sub_u32 s68, s61, s67
    s_mov_b32 s67, s61
    v_mfma_f32_16x16x32_bf16 v[146:149], v[114:117], v[102:105], v[146:149]
    ds_read_b64_tr_b16 v[218:219], v5 offset:0
    v_mfma_f32_4x4x4_16b_bf16 v[32:35], v[62:63], v[126:127], v[32:35]
    v_mfma_f32_16x16x32_bf16 v[162:165], v[114:117], v[106:109], v[162:165]
    ds_read_b64_tr_b16 v[220:221], v5 offset:512
    v_mfma_f32_16x16x32_bf16 v[166:169], v[118:121], v[106:109], v[166:169]
    ds_read_b128 v[206:209], v2 offset:6144
    v_mfma_f32_4x4x4_16b_bf16 v[20:23], v[62:63], v[116:117], v[20:23]
    v_mfma_f32_16x16x32_bf16 v[170:173], v[122:125], v[106:109], v[170:173]
    ds_read_b64_tr_b16 v[222:223], v6 offset:0
    buffer_load_dwordx4 v9, s[24:27], s58 offen offset:1024 lds
    v_mfma_f32_16x16x32_bf16 v[174:177], v[126:129], v[106:109], v[174:177]
    ds_read_b64_tr_b16 v[224:225], v6 offset:512
    v_mfma_f32_4x4x4_16b_bf16 v[24:27], v[62:63], v[120:121], v[24:27]
    v_mfma_f32_16x16x32_bf16 v[190:193], v[126:129], v[110:113], v[190:193]
    v_mfma_f32_16x16x32_bf16 v[186:189], v[122:125], v[110:113], v[186:189]
    v_mfma_f32_4x4x4_16b_bf16 v[28:31], v[62:63], v[124:125], v[28:31]
    v_mfma_f32_16x16x32_bf16 v[182:185], v[118:121], v[110:113], v[182:185]
    buffer_load_dwordx4 v10, s[24:27], s58 offen offset:2048 lds
    v_mfma_f32_16x16x32_bf16 v[178:181], v[114:117], v[110:113], v[178:181]
    v_mfma_f32_4x4x4_16b_bf16 v[32:35], v[62:63], v[128:129], v[32:35]
    s_waitcnt lgkmcnt(0)
    v_mfma_f32_16x16x32_bf16 v[130:133], v[210:213], v[194:197], v[130:133]
    ds_read_b128 v[98:101], v2 offset:512
    s_setprio 0
    buffer_load_dwordx4 v11, s[24:27], s58 offen offset:3072 lds
    v_mfma_f32_16x16x32_bf16 v[134:137], v[214:217], v[194:197], v[134:137]
    ds_read_b64_tr_b16 v[114:115], v3 offset:4096
    v_mfma_f32_4x4x4_16b_bf16 v[20:23], v[62:63], v[210:211], v[20:23]
    v_mfma_f32_16x16x32_bf16 v[138:141], v[218:221], v[194:197], v[138:141]
    ds_read_b64_tr_b16 v[116:117], v3 offset:4608
    v_mfma_f32_16x16x32_bf16 v[142:145], v[222:225], v[194:197], v[142:145]
    ds_read_b128 v[102:105], v2 offset:2560
    v_mfma_f32_4x4x4_16b_bf16 v[24:27], v[62:63], v[214:215], v[24:27]
    v_mfma_f32_16x16x32_bf16 v[158:161], v[222:225], v[198:201], v[158:161]
    ds_read_b64_tr_b16 v[118:119], v4 offset:4096
    s_add_u32 m0, s54, s70
    s_mul_i32 s59, s52, s56
    buffer_load_dwordx4 v12, s[28:31], s59 offen lds
    v_mfma_f32_16x16x32_bf16 v[154:157], v[218:221], v[198:201], v[154:157]
    ds_read_b64_tr_b16 v[120:121], v4 offset:4608
    v_mfma_f32_4x4x4_16b_bf16 v[28:31], v[62:63], v[218:219], v[28:31]
    v_mfma_f32_16x16x32_bf16 v[150:153], v[214:217], v[198:201], v[150:153]
    ds_read_b128 v[106:109], v2 offset:4608
    v_mfma_f32_16x16x32_bf16 v[146:149], v[210:213], v[198:201], v[146:149]
    ds_read_b64_tr_b16 v[122:123], v5 offset:4096
    v_mfma_f32_4x4x4_16b_bf16 v[32:35], v[62:63], v[222:223], v[32:35]
    v_mfma_f32_16x16x32_bf16 v[162:165], v[210:213], v[202:205], v[162:165]
    ds_read_b64_tr_b16 v[124:125], v5 offset:4608
    buffer_load_dwordx4 v13, s[28:31], s59 offen offset:1024 lds
    v_mfma_f32_16x16x32_bf16 v[166:169], v[214:217], v[202:205], v[166:169]
    ds_read_b128 v[110:113], v2 offset:6656
    v_mfma_f32_4x4x4_16b_bf16 v[20:23], v[62:63], v[212:213], v[20:23]
    v_mfma_f32_16x16x32_bf16 v[170:173], v[218:221], v[202:205], v[170:173]
    ds_read_b64_tr_b16 v[126:127], v6 offset:4096
    v_mfma_f32_16x16x32_bf16 v[174:177], v[222:225], v[202:205], v[174:177]
    ds_read_b64_tr_b16 v[128:129], v6 offset:4608
    v_mfma_f32_4x4x4_16b_bf16 v[24:27], v[62:63], v[216:217], v[24:27]
    v_mfma_f32_16x16x32_bf16 v[190:193], v[222:225], v[206:209], v[190:193]
    s_add_u32 m0, s54, s71
    s_mul_i32 s59, s52, 245760
    s_mov_b64 exec, 0xffff
    buffer_load_dwordx4 v14, s[32:35], s59 offen lds
    s_mov_b64 exec, -1
    v_add_u32 v2, s68, v2
    v_add_u32 v3, s68, v3
    v_mfma_f32_16x16x32_bf16 v[186:189], v[218:221], v[206:209], v[186:189]
    s_add_u32 s52, s52, 1
    s_cmp_eq_u32 s52, 10
    s_cselect_b32 s52, 0, s52
    s_add_u32 s54, s54, 50176
    s_cmp_eq_u32 s54, 150528
    s_cselect_b32 s54, 0, s54
    v_add_u32 v4, s68, v4
    v_add_u32 v5, s68, v5
    v_mfma_f32_4x4x4_16b_bf16 v[28:31], v[62:63], v[220:221], v[28:31]
    v_mfma_f32_16x16x32_bf16 v[182:185], v[214:217], v[206:209], v[182:185]
    v_add_u32 v6, s68, v6
    s_sub_u32 s53, s53, 1
    s_cmp_gt_u32 s53, 8
    v_mfma_f32_16x16x32_bf16 v[178:181], v[210:213], v[206:209], v[178:181]
    v_mfma_f32_4x4x4_16b_bf16 v[32:35], v[62:63], v[224:225], v[32:35]
    s_cbranch_scc1 L_P1b_h
    s_waitcnt lgkmcnt(0)
    v_mfma_f32_4x4x4_16b_bf16 v[20:23], v[62:63], v[114:115], v[20:23]
    v_mfma_f32_4x4x4_16b_bf16 v[24:27], v[62:63], v[118:119], v[24:27]
    v_mfma_f32_4x4x4_16b_bf16 v[28:31], v[62:63], v[122:123], v[28:31]
    v_mfma_f32_4x4x4_16b_bf16 v[32:35], v[62:63], v[126:127], v[32:35]
    v_mfma_f32_4x4x4_16b_bf16 v[20:23], v[62:63], v[116:117], v[20:23]
    v_mfma_f32_4x4x4_16b_bf16 v[24:27], v[62:63], v[120:121], v[24:27]
    v_mfma_f32_4x4x4_16b_bf16 v[28:31], v[62:63], v[124:125], v[28:31]
    v_mfma_f32_4x4x4_16b_bf16 v[32:35], v[62:63], v[128:129], v[32:35]
    s_lshl_b32 s58, s50, 9
    v_mov_b32 v245, s64
    s_nop 2
    v_permlane16_swap_b32 v20, v24
    v_permlane16_swap_b32 v28, v32
    v_add_f32 v20, v20, v24
    v_add_f32 v28, v28, v32
    s_nop 1
    v_permlane32_swap_b32 v20, v28
    v_add_f32 v244, v20, v28
    buffer_store_dwordx2 v[244:245], v83, s[36:39], s58 offen sc1
.p2align 3
L_P1b:
    s_waitcnt vmcnt(7) lgkmcnt(0)
    s_barrier
L_P1b_in:
    v_mfma_f32_16x16x32_bf16 v[130:133], v[114:117], v[98:101], v[130:133]
    ds_read_b128 v[194:197], v2 offset:0
    s_setprio 1
    v_mfma_f32_16x16x32_bf16 v[134:137], v[118:121], v[98:101], v[134:137]
    ds_read_b64_tr_b16 v[210:211], v3 offset:0
    v_mfma_f32_16x16x32_bf16 v[138:141], v[122:125], v[98:101], v[138:141]
    ds_read_b64_tr_b16 v[212:213], v3 offset:512
    v_mfma_f32_16x16x32_bf16 v[142:145], v[126:129], v[98:101], v[142:145]
    ds_read_b128 v[198:201], v2 offset:2048
    v_mfma_f32_16x16x32_bf16 v[158:161], v[126:129], v[102:105], v[158:161]
    ds_read_b64_tr_b16 v[214:215], v4 offset:0
    s_lshl_b32 s58, s52, 7
    s_add_u32 m0, s54, s69
    s_add_u32 s58, s58, s55
    buffer_load_dwordx4 v8, s[24:27], s58 offen offset:0 lds
    v_mfma_f32_16x16x32_bf16 v[154:157], v[122:125], v[102:105], v[154:157]
    ds_read_b64_tr_b16 v[216:217], v4 offset:512
    v_mfma_f32_16x16x32_bf16 v[150:153], v[118:121], v[102:105], v[150:153]
    ds_read_b128 v[202:205], v2 offset:4096
    s_add_u32 s61, s67, 50176
    s_cmp_eq_u32 s61, 150528
    s_cselect_b32 s61, 0, s61
    s_sub_u32 s68, s61, s67
    s_mov_b32 s67, s61
    v_mfma_f32_16x16x32_bf16 v[146:149], v[114:117], v[102:105], v[146:149]
    ds_read_b64_tr_b16 v[218:219], v5 offset:0
    v_mfma_f32_16x16x32_bf16 v[162:165], v[114:117], v[106:109], v[162:165]
    ds_read_b64_tr_b16 v[220:221], v5 offset:512
    v_mfma_f32_16x16x32_bf16 v[166:169], v[118:121], v[106:109], v[166:169]
    ds_read_b128 v[206:209], v2 offset:6144
    v_mfma_f32_16x16x32_bf16 v[170:173], v[122:125], v[106:109], v[170:173]
    ds_read_b64_tr_b16 v[222:223], v6 offset:0
    buffer_load_dwordx4 v9, s[24:27], s58 offen offset:1024 lds
    v_mfma_f32_16x16x32_bf16 v[174:177], v[126:129], v[106:109], v[174:177]
    ds_read_b64_tr_b16 v[224:225], v6 offset:512
    v_mfma_f32_16x16x32_bf16 v[190:193], v[126:129], v[110:113], v[190:193]
    v_mfma_f32_16x16x32_bf16 v[186:189], v[122:125], v[110:113], v[186:189]
    v_mfma_f32_16x16x32_bf16 v[182:185], v[118:121], v[110:113], v[182:185]
    buffer_load_dwordx4 v10, s[24:27], s58 offen offset:2048 lds
    v_mfma_f32_16x16x32_bf16 v[178:181], v[114:117], v[110:113], v[178:181]
    s_waitcnt lgkmcnt(0)
    v_mfma_f32_16x16x32_bf16 v[130:133], v[210:213], v[194:197], v[130:133]
    ds_read_b128 v[98:101], v2 offset:512
    s_setprio 0
    buffer_load_dwordx4 v11, s[24:27], s58 offen offset:3072 lds
    v_mfma_f32_16x16x32_bf16 v[134:137], v[214:217], v[194:197], v[134:137]
    ds_read_b64_tr_b16 v[114:115], v3 offset:4096
    v_mfma_f32_16x16x32_bf16 v[138:141], v[218:221], v[194:197], v[138:141]
    ds_read_b64_tr_b16 v[116:117], v3 offset:4608
    v_mfma_f32_16x16x32_bf16 v[142:145], v[222:225], v[194:197], v[142:145]
    ds_read_b128 v[102:105], v2 offset:2560
    v_mfma_f32_16x16x32_bf16 v[158:161], v[222:225], v[198:201], v[158:161]
    ds_read_b64_tr_b16 v[118:119], v4 offset:4096
    s_add_u32 m0, s54, s70
    s_mul_i32 s59, s52, s56
    buffer_load_dwordx4 v12, s[28:31], s59 offen lds
    v_mfma_f32_16x16x32_bf16 v[154:157], v[218:221], v[198:201], v[154:157]
    ds_read_b64_tr_b16 v[120:121], v4 offset:4608
    v_mfma_f32_16x16x32_bf16 v[150:153], v[214:217], v[198:201], v[150:153]
    ds_read_b128 v[106:109], v2 offset:4608
    v_mfma_f32_16x16x32_bf16 v[146:149], v[210:213], v[198:201], v[146:149]
    ds_read_b64_tr_b16 v[122:123], v5 offset:4096
    v_mfma_f32_16x16x32_bf16 v[162:165], v[210:213], v[202:205], v[162:165]
    ds_read_b64_tr_b16 v[124:125], v5 offset:4608
    buffer_load_dwordx4 v13, s[28:31], s59 offen offset:1024 lds
    v_mfma_f32_16x16x32_bf16 v[166:169], v[214:217], v[202:205], v[166:169]
    ds_read_b128 v[110:113], v2 offset:6656
    v_mfma_f32_16x16x32_bf16 v[170:173], v[218:221], v[202:205], v[170:173]
    ds_read_b64_tr_b16 v[126:127], v6 offset:4096
    v_mfma_f32_16x16x32_bf16 v[174:177], v[222:225], v[202:205], v[174:177]
    ds_read_b64_tr_b16 v[128:129], v6 offset:4608
    v_mfma_f32_16x16x32_bf16 v[190:193], v[222:225], v[206:209], v[190:193]
    s_add_u32 m0, s54, s71
    s_mul_i32 s59, s52, 245760
    s_mov_b64 exec, 0xffff
    buffer_load_dwordx4 v14, s[32:35], s59 offen lds
    s_mov_b64 exec, -1
    v_add_u32 v2, s68, v2
    v_add_u32 v3, s68, v3
    v_mfma_f32_16x16x32_bf16 v[186:189], v[218:221], v[206:209], v[186:189]
    s_add_u32 s52, s52, 1
    s_cmp_eq_u32 s52, 10
    s_cselect_b32 s52, 0, s52
    s_add_u32 s54, s54, 50176
    s_cmp_eq_u32 s54, 150528
    s_cselect_b32 s54, 0, s54
    v_add_u32 v4, s68, v4
    v_add_u32 v5, s68, v5
    v_mfma_f32_16x16x32_bf16 v[182:185], v[214:217], v[206:209], v[182:185]
    v_add_u32 v6, s68, v6
    s_sub_u32 s53, s53, 1
    s_cmp_gt_u32 s53, 2
    v_mfma_f32_16x16x32_bf16 v[178:181], v[210:213], v[206:209], v[178:181]
    s_cbranch_scc1 L_P1b
    s_waitcnt vmcnt(7) lgkmcnt(0)
    s_barrier
    buffer_load_dwordx4 v[36:39], v82, s[36:39], 0 offen offset:0 sc1
    buffer_load_dwordx4 v[40:43], v82, s[36:39], 0 offen offset:1024 sc1
    buffer_load_dwordx4 v[44:47], v82, s[36:39], 0 offen offset:2048 sc1
    buffer_load_dwordx4 v[48:51], v82, s[36:39], 0 offen offset:3072 sc1
    buffer_load_dwordx2 v[52:53], v83, s[36:39], 0 offen offset:0 sc1
    buffer_load_dwordx2 v[54:55], v83, s[36:39], 0 offen offset:512 sc1
    buffer_load_dwordx2 v[56:57], v83, s[36:39], 0 offen offset:1024 sc1
    buffer_load_dwordx2 v[58:59], v83, s[36:39], 0 offen offset:1536 sc1
    buffer_load_dwordx2 v[60:61], v83, s[36:39], 0 offen offset:2048 sc1
    s_branch L_P1b_tin
L_P1b_t:
    s_waitcnt vmcnt(10) lgkmcnt(0)
    s_barrier
L_P1b_tin:
    v_mfma_f32_16x16x32_bf16 v[130:133], v[114:117], v[98:101], v[130:133]
    ds_read_b128 v[194:197], v2 offset:0
    s_setprio 0
    v_mfma_f32_16x16x32_bf16 v[134:137], v[118:121], v[98:101], v[134:137]
    ds_read_b64_tr_b16 v[210:211], v3 offset:0
    v_mfma_f32_16x16x32_bf16 v[138:141], v[122:125], v[98:101], v[138:141]
    ds_read_b64_tr_b16 v[212:213], v3 offset:512
    v_mfma_f32_16x16x32_bf16 v[142:145], v[126:129], v[98:101], v[142:145]
    ds_read_b128 v[198:201], v2 offset:2048
    v_mfma_f32_16x16x32_bf16 v[158:161], v[126:129], v[102:105], v[158:161]
    ds_read_b64_tr_b16 v[214:215], v4 offset:0
    v_mfma_f32_16x16x32_bf16 v[154:157], v[122:125], v[102:105], v[154:157]
    ds_read_b64_tr_b16 v[216:217], v4 offset:512
    v_mfma_f32_16x16x32_bf16 v[150:153], v[118:121], v[102:105], v[150:153]
    ds_read_b128 v[202:205], v2 offset:4096
    s_add_u32 s61, s67, 50176
    s_cmp_eq_u32 s61, 150528
    s_cselect_b32 s61, 0, s61
    s_sub_u32 s68, s61, s67
    s_mov_b32 s67, s61
    v_mfma_f32_16x16x32_bf16 v[146:149], v[114:117], v[102:105], v[146:149]
    ds_read_b64_tr_b16 v[218:219], v5 offset:0
    v_mfma_f32_16x16x32_bf16 v[162:165], v[114:117], v[106:109], v[162:165]
    ds_read_b64_tr_b16 v[220:221], v5 offset:512
    v_mfma_f32_16x16x32_bf16 v[166:169], v[118:121], v[106:109], v[166:169]
    ds_read_b128 v[206:209], v2 offset:6144
    v_mfma_f32_16x16x32_bf16 v[170:173], v[122:125], v[106:109], v[170:173]
    ds_read_b64_tr_b16 v[222:223], v6 offset:0
    v_mfma_f32_16x16x32_bf16 v[174:177], v[126:129], v[106:109], v[174:177]
    ds_read_b64_tr_b16 v[224:225], v6 offset:512
    v_mfma_f32_16x16x32_bf16 v[190:193], v[126:129], v[110:113], v[190:193]
    v_mfma_f32_16x16x32_bf16 v[186:189], v[122:125], v[110:113], v[186:189]
    v_mfma_f32_16x16x32_bf16 v[182:185], v[118:121], v[110:113], v[182:185]
    buffer_load_dword v19, v18, s[44:47], s62 offen
    s_mov_b32 s62, 0x40000000
    v_mfma_f32_16x16x32_bf16 v[178:181], v[114:117], v[110:113], v[178:181]
    s_waitcnt lgkmcnt(0)
    v_mfma_f32_16x16x32_bf16 v[130:133], v[210:213], v[194:197], v[130:133]
    ds_read_b128 v[98:101], v2 offset:512
    v_mfma_f32_16x16x32_bf16 v[134:137], v[214:217], v[194:197], v[134:137]
    ds_read_b64_tr_b16 v[114:115], v3 offset:4096
    v_mfma_f32_16x16x32_bf16 v[138:141], v[218:221], v[194:197], v[138:141]
    ds_read_b64_tr_b16 v[116:117], v3 offset:4608
    v_mfma_f32_16x16x32_bf16 v[142:145], v[222:225], v[194:197], v[142:145]
    ds_read_b128 v[102:105], v2 offset:2560
    v_mfma_f32_16x16x32_bf16 v[158:161], v[222:225], v[198:201], v[158:161]
    ds_read_b64_tr_b16 v[118:119], v4 offset:4096
    v_mfma_f32_16x16x32_bf16 v[154:157], v[218:221], v[198:201], v[154:157]
    ds_read_b64_tr_b16 v[120:121], v4 offset:4608
    v_mfma_f32_16x16x32_bf16 v[150:153], v[214:217], v[198:201], v[150:153]
    ds_read_b128 v[106:109], v2 offset:4608
    v_mfma_f32_16x16x32_bf16 v[146:149], v[210:213], v[198:201], v[146:149]
    ds_read_b64_tr_b16 v[122:123], v5 offset:4096
    v_mfma_f32_16x16x32_bf16 v[162:165], v[210:213], v[202:205], v[162:165]
    ds_read_b64_tr_b16 v[124:125], v5 offset:4608
    v_mfma_f32_16x16x32_bf16 v[166:169], v[214:217], v[202:205], v[166:169]
    ds_read_b128 v[110:113], v2 offset:6656
    v_mfma_f32_16x16x32_bf16 v[170:173], v[218:221], v[202:205], v[170:173]
    ds_read_b64_tr_b16 v[126:127], v6 offset:4096
    v_mfma_f32_16x16x32_bf16 v[174:177], v[222:225], v[202:205], v[174:177]
    ds_read_b64_tr_b16 v[128:129], v6 offset:4608
    v_mfma_f32_16x16x32_bf16 v[190:193], v[222:225], v[206:209], v[190:193]
    v_add_u32 v2, s68, v2
    v_add_u32 v3, s68, v3
    v_mfma_f32_16x16x32_bf16 v[186:189], v[218:221], v[206:209], v[186:189]
    v_add_u32 v4, s68, v4
    v_add_u32 v5, s68, v5
    v_mfma_f32_16x16x32_bf16 v[182:185], v[214:217], v[206:209], v[182:185]
    v_add_u32 v6, s68, v6
    s_sub_u32 s53, s53, 1
    s_cmp_lg_u32 s53, 0
    v_mfma_f32_16x16x32_bf16 v[178:181], v[210:213], v[206:209], v[178:181]
    s_cbranch_scc1 L_P1b_t
    s_waitcnt vmcnt(2)
    s_mov_b32 s83, 0x100000
L_P1b_chk:
    v_cmp_eq_u64 s[58:59], s[64:65], v[38:39]
    v_cmp_eq_u64 vcc, s[64:65], v[42:43]
    v_add_f32 v244, v52, v54
    v_add_f32 v245, v56, v58
    s_and_b64 s[58:59], s[58:59], vcc
    v_cmp_eq_u64 s[60:61], s[64:65], v[46:47]
    v_cmp_eq_u64 vcc, s[64:65], v[50:51]
    s_nop 0
    s_and_b64 s[58:59], s[58:59], s[60:61]
    s_and_b64 s[58:59], s[58:59], vcc
    v_xor_b32 v246, v53, v55
    v_xor_b32 v247, v57, v59
    v_xor_b32 v248, v53, v61
    v_xor_b32 v249, v53, v57
    v_or3_b32 v246, v246, v247, v248
    v_xor_b32 v247, s64, v53
    v_or3_b32 v246, v246, v247, v249
    v_cmp_eq_u32 vcc, 0, v246
    v_add_f32 v244, v244, v60
    v_add_f32 v244, v244, v245
    s_and_b64 s[58:59], s[58:59], vcc
    s_cmp_eq_u64 s[58:59], -1
    s_cbranch_scc0 L_P1b_again
    s_waitcnt lgkmcnt(0)
    ds_write_b32 v64, v244
    ds_read_b128 v[194:197], v65 offset:0
    ds_read_b128 v[198:201], v65 offset:64
    ds_read_b128 v[202:205], v65 offset:128
    ds_read_b128 v[206:209], v65 offset:192
    v_mfma_f32_16x16x32_bf16 v[130:133], v[114:117], v[98:101], v[130:133]
    s_setprio 0
    v_mfma_f32_16x16x32_bf16 v[134:137], v[118:121], v[98:101], v[134:137]
    v_mfma_f32_16x16x32_bf16 v[138:141], v[122:125], v[98:101], v[138:141]
    v_mfma_f32_16x16x32_bf16 v[142:145], v[126:129], v[98:101], v[142:145]
    v_mfma_f32_16x16x32_bf16 v[158:161], v[126:129], v[102:105], v[158:161]
    v_mfma_f32_16x16x32_bf16 v[154:157], v[122:125], v[102:105], v[154:157]
    v_mfma_f32_16x16x32_bf16 v[150:153], v[118:121], v[102:105], v[150:153]
    v_mfma_f32_16x16x32_bf16 v[146:149], v[114:117], v[102:105], v[146:149]
    v_mfma_f32_16x16x32_bf16 v[162:165], v[114:117], v[106:109], v[162:165]
    v_mfma_f32_16x16x32_bf16 v[166:169], v[118:121], v[106:109], v[166:169]
    v_mfma_f32_16x16x32_bf16 v[170:173], v[122:125], v[106:109], v[170:173]
    v_mfma_f32_16x16x32_bf16 v[174:177], v[126:129], v[106:109], v[174:177]
    v_mfma_f32_16x16x32_bf16 v[190:193], v[126:129], v[110:113], v[190:193]
    v_mfma_f32_16x16x32_bf16 v[186:189], v[122:125], v[110:113], v[186:189]
    v_mfma_f32_16x16x32_bf16 v[182:185], v[118:121], v[110:113], v[182:185]
    v_mfma_f32_16x16x32_bf16 v[178:181], v[114:117], v[110:113], v[178:181]
    s_waitcnt lgkmcnt(0)
    s_nop 4
    v_pk_fma_f32 v[130:131], v[194:195], v[36:37], v[130:131] op_sel_hi:[1,0,1] neg_lo:[0,1,0] neg_hi:[0,1,0]
    v_pk_fma_f32 v[132:133], v[196:197], v[36:37], v[132:133] op_sel_hi:[1,0,1] neg_lo:[0,1,0] neg_hi:[0,1,0]
    v_pk_fma_f32 v[134:135], v[198:199], v[36:37], v[134:135] op_sel_hi:[1,0,1] neg_lo:[0,1,0] neg_hi:[0,1,0]
    v_pk_fma_f32 v[136:137], v[200:201], v[36:37], v[136:137] op_sel_hi:[1,0,1] neg_lo:[0,1,0] neg_hi:[0,1,0]
    v_pk_fma_f32 v[138:139], v[202:203], v[36:37], v[138:139] op_sel_hi:[1,0,1] neg_lo:[0,1,0] neg_hi:[0,1,0]
    v_pk_fma_f32 v[140:141], v[204:205], v[36:37], v[140:141] op_sel_hi:[1,0,1] neg_lo:[0,1,0] neg_hi:[0,1,0]
    v_pk_fma_f32 v[142:143], v[206:207], v[36:37], v[142:143] op_sel_hi:[1,0,1] neg_lo:[0,1,0] neg_hi:[0,1,0]
    v_pk_fma_f32 v[144:145], v[208:209], v[36:37], v[144:145] op_sel_hi:[1,0,1] neg_lo:[0,1,0] neg_hi:[0,1,0]
    v_pk_mul_f32 v[130:131], v[130:131], v[36:37] op_sel:[0,1] op_sel_hi:[1,1]
    v_pk_mul_f32 v[132:133], v[132:133], v[36:37] op_sel:[0,1] op_sel_hi:[1,1]
    v_pk_mul_f32 v[134:135], v[134:135], v[36:37] op_sel:[0,1] op_sel_hi:[1,1]
    v_pk_mul_f32 v[136:137], v[136:137], v[36:37] op_sel:[0,1] op_sel_hi:[1,1]
    v_pk_mul_f32 v[138:139], v[138:139], v[36:37] op_sel:[0,1] op_sel_hi:[1,1]
    v_pk_mul_f32 v[140:141], v[140:141], v[36:37] op_sel:[0,1] op_sel_hi:[1,1]
    v_pk_mul_f32 v[142:143], v[142:143], v[36:37] op_sel:[0,1] op_sel_hi:[1,1]
    v_pk_mul_f32 v[144:145], v[144:145], v[36:37] op_sel:[0,1] op_sel_hi:[1,1]
    v_cvt_pk_bf16_f32 v130, v130, v131
    v_cvt_pk_bf16_f32 v131, v132, v133
    v_cvt_pk_bf16_f32 v132, v134, v135
    v_cvt_pk_bf16_f32 v133, v136, v137
    v_pk_max_i16 v130, v130, 0
    v_pk_max_i16 v131, v131, 0
    v_pk_max_i16 v132, v132, 0
    v_pk_max_i16 v133, v133, 0
    v_cvt_pk_bf16_f32 v138, v138, v139
    v_cvt_pk_bf16_f32 v139, v140, v141
    v_cvt_pk_bf16_f32 v140, v142, v143
    v_cvt_pk_bf16_f32 v141, v144, v145
    v_pk_max_i16 v138, v138, 0
    v_pk_max_i16 v139, v139, 0
    v_pk_max_i16 v140, v140, 0
    v_pk_max_i16 v141, v141, 0
    v_pk_fma_f32 v[146:147], v[194:195], v[40:41], v[146:147] op_sel_hi:[1,0,1] neg_lo:[0,1,0] neg_hi:[0,1,0]
    v_pk_fma_f32 v[148:149], v[196:197], v[40:41], v[148:149] op_sel_hi:[1,0,1] neg_lo:[0,1,0] neg_hi:[0,1,0]
    v_pk_fma_f32 v[150:151], v[198:199], v[40:41], v[150:151] op_sel_hi:[1,0,1] neg_lo:[0,1,0] neg_hi:[0,1,0]
    v_pk_fma_f32 v[152:153], v[200:201], v[40:41], v[152:153] op_sel_hi:[1,0,1] neg_lo:[0,1,0] neg_hi:[0,1,0]
    v_pk_fma_f32 v[154:155], v[202:203], v[40:41], v[154:155] op_sel_hi:[1,0,1] neg_lo:[0,1,0] neg_hi:[0,1,0]
    v_pk_fma_f32 v[156:157], v[204:205], v[40:41], v[156:157] op_sel_hi:[1,0,1] neg_lo:[0,1,0] neg_hi:[0,1,0]
    v_pk_fma_f32 v[158:159], v[206:207], v[40:41], v[158:159] op_sel_hi:[1,0,1] neg_lo:[0,1,0] neg_hi:[0,1,0]
    v_pk_fma_f32 v[160:161], v[208:209], v[40:41], v[160:161] op_sel_hi:[1,0,1] neg_lo:[0,1,0] neg_hi:[0,1,0]
    v_pk_mul_f32 v[146:147], v[146:147], v[40:41] op_sel:[0,1] op_sel_hi:[1,1]
    v_pk_mul_f32 v[148:149], v[148:149], v[40:41] op_sel:[0,1] op_sel_hi:[1,1]
    v_pk_mul_f32 v[150:151], v[150:151], v[40:41] op_sel:[0,1] op_sel_hi:[1,1]
    v_pk_mul_f32 v[152:153], v[152:153], v[40:41] op_sel:[0,1] op_sel_hi:[1,1]
    v_pk_mul_f32 v[154:155], v[154:155], v[40:41] op_sel:[0,1] op_sel_hi:[1,1]
    v_pk_mul_f32 v[156:157], v[156:157], v[40:41] op_sel:[0,1] op_sel_hi:[1,1]
    v_pk_mul_f32 v[158:159], v[158:159], v[40:41] op_sel:[0,1] op_sel_hi:[1,1]
    v_pk_mul_f32 v[160:161], v[160:161], v[40:41] op_sel:[0,1] op_sel_hi:[1,1]
    v_cvt_pk_bf16_f32 v146, v146, v147
    v_cvt_pk_bf16_f32 v147, v148, v149
    v_cvt_pk_bf16_f32 v148, v150, v151
    v_cvt_pk_bf16_f32 v149, v152, v153
    v_pk_max_i16 v146, v146, 0
    v_pk_max_i16 v147, v147, 0
    v_pk_max_i16 v148, v148, 0
    v_pk_max_i16 v149, v149, 0
    v_cvt_pk_bf16_f32 v154, v154, v155
    v_cvt_pk_bf16_f32 v155, v156, v157
    v_cvt_pk_bf16_f32 v156, v158, v159
    v_cvt_pk_bf16_f32 v157, v160, v161
    v_pk_max_i16 v154, v154, 0
    v_pk_max_i16 v155, v155, 0
    v_pk_max_i16 v156, v156, 0
    v_pk_max_i16 v157, v157, 0
    v_pk_fma_f32 v[162:163], v[194:195], v[44:45], v[162:163] op_sel_hi:[1,0,1] neg_lo:[0,1,0] neg_hi:[0,1,0]
    v_pk_fma_f32 v[164:165], v[196:197], v[44:45], v[164:165] op_sel_hi:[1,0,1] neg_lo:[0,1,0] neg_hi:[0,1,0]
    v_pk_fma_f32 v[166:167], v[198:199], v[44:45], v[166:167] op_sel_hi:[1,0,1] neg_lo:[0,1,0] neg_hi:[0,1,0]
    v_pk_fma_f32 v[168:169], v[200:201], v[44:45], v[168:169] op_sel_hi:[1,0,1] neg_lo:[0,1,0] neg_hi:[0,1,0]
    v_pk_fma_f32 v[170:171], v[202:203], v[44:45], v[170:171] op_sel_hi:[1,0,1] neg_lo:[0,1,0] neg_hi:[0,1,0]
    v_pk_fma_f32 v[172:173], v[204:205], v[44:45], v[172:173] op_sel_hi:[1,0,1] neg_lo:[0,1,0] neg_hi:[0,1,0]
    v_pk_fma_f32 v[174:175], v[206:207], v[44:45], v[174:175] op_sel_hi:[1,0,1] neg_lo:[0,1,0] neg_hi:[0,1,0]
    v_pk_fma_f32 v[176:177], v[208:209], v[44:45], v[176:177] op_sel_hi:[1,0,1] neg_lo:[0,1,0] neg_hi:[0,1,0]
    v_pk_mul_f32 v[162:163], v[162:163], v[44:45] op_sel:[0,1] op_sel_hi:[1,1]
    v_pk_mul_f32 v[164:165], v[164:165], v[44:45] op_sel:[0,1] op_sel_hi:[1,1]
    v_pk_mul_f32 v[166:167], v[166:167], v[44:45] op_sel:[0,1] op_sel_hi:[1,1]
    v_pk_mul_f32 v[168:169], v[168:169], v[44:45] op_sel:[0,1] op_sel_hi:[1,1]
    v_pk_mul_f32 v[170:171], v[170:171], v[44:45] op_sel:[0,1] op_sel_hi:[1,1]
    v_pk_mul_f32 v[172:173], v[172:173], v[44:45] op_sel:[0,1] op_sel_hi:[1,1]
    v_pk_mul_f32 v[174:175], v[174:175], v[44:45] op_sel:[0,1] op_sel_hi:[1,1]
    v_pk_mul_f32 v[176:177], v[176:177], v[44:45] op_sel:[0,1] op_sel_hi:[1,1]
    v_cvt_pk_bf16_f32 v162, v162, v163
    v_cvt_pk_bf16_f32 v163, v164, v165
    v_cvt_pk_bf16_f32 v164, v166, v167
    v_cvt_pk_bf16_f32 v165, v168, v169
    v_pk_max_i16 v162, v162, 0
    v_pk_max_i16 v163, v163, 0
    v_pk_max_i16 v164, v164, 0
    v_pk_max_i16 v165, v165, 0
    v_cvt_pk_bf16_f32 v170, v170, v171
    v_cvt_pk_bf16_f32 v171, v172, v173
    v_cvt_pk_bf16_f32 v172, v174, v175
    v_cvt_pk_bf16_f32 v173, v176, v177
    v_pk_max_i16 v170, v170, 0
    v_pk_max_i16 v171, v171, 0
    v_pk_max_i16 v172, v172, 0
    v_pk_max_i16 v173, v173, 0
    v_pk_fma_f32 v[178:179], v[194:195], v[48:49], v[178:179] op_sel_hi:[1,0,1] neg_lo:[0,1,0] neg_hi:[0,1,0]
    v_pk_fma_f32 v[180:181], v[196:197], v[48:49], v[180:181] op_sel_hi:[1,0,1] neg_lo:[0,1,0] neg_hi:[0,1,0]
    v_pk_fma_f32 v[182:183], v[198:199], v[48:49], v[182:183] op_sel_hi:[1,0,1] neg_lo:[0,1,0] neg_hi:[0,1,0]
    v_pk_fma_f32 v[184:185], v[200:201], v[48:49], v[184:185] op_sel_hi:[1,0,1] neg_lo:[0,1,0] neg_hi:[0,1,0]
    v_pk_fma_f32 v[186:187], v[202:203], v[48:49], v[186:187] op_sel_hi:[1,0,1] neg_lo:[0,1,0] neg_hi:[0,1,0]
    v_pk_fma_f32 v[188:189], v[204:205], v[48:49], v[188:189] op_sel_hi:[1,0,1] neg_lo:[0,1,0] neg_hi:[0,1,0]
    v_pk_fma_f32 v[190:191], v[206:207], v[48:49], v[190:191] op_sel_hi:[1,0,1] neg_lo:[0,1,0] neg_hi:[0,1,0]
    v_pk_fma_f32 v[192:193], v[208:209], v[48:49], v[192:193] op_sel_hi:[1,0,1] neg_lo:[0,1,0] neg_hi:[0,1,0]
    v_pk_mul_f32 v[178:179], v[178:179], v[48:49] op_sel:[0,1] op_sel_hi:[1,1]
    v_pk_mul_f32 v[180:181], v[180:181], v[48:49] op_sel:[0,1] op_sel_hi:[1,1]
    v_pk_mul_f32 v[182:183], v[182:183], v[48:49] op_sel:[0,1] op_sel_hi:[1,1]
    v_pk_mul_f32 v[184:185], v[184:185], v[48:49] op_sel:[0,1] op_sel_hi:[1,1]
    v_pk_mul_f32 v[186:187], v[186:187], v[48:49] op_sel:[0,1] op_sel_hi:[1,1]
    v_pk_mul_f32 v[188:189], v[188:189], v[48:49] op_sel:[0,1] op_sel_hi:[1,1]
    v_pk_mul_f32 v[190:191], v[190:191], v[48:49] op_sel:[0,1] op_sel_hi:[1,1]
    v_pk_mul_f32 v[192:193], v[192:193], v[48:49] op_sel:[0,1] op_sel_hi:[1,1]
    v_cvt_pk_bf16_f32 v178, v178, v179
    v_cvt_pk_bf16_f32 v179, v180, v181
    v_cvt_pk_bf16_f32 v180, v182, v183
    v_cvt_pk_bf16_f32 v181, v184, v185
    v_pk_max_i16 v178, v178, 0
    v_pk_max_i16 v179, v179, 0
    v_pk_max_i16 v180, v180, 0
    v_pk_max_i16 v181, v181, 0
    v_cvt_pk_bf16_f32 v186, v186, v187
    v_cvt_pk_bf16_f32 v187, v188, v189
    v_cvt_pk_bf16_f32 v188, v190, v191
    v_cvt_pk_bf16_f32 v189, v192, v193
    v_pk_max_i16 v186, v186, 0
    v_pk_max_i16 v187, v187, 0
    v_pk_max_i16 v188, v188, 0
    v_pk_max_i16 v189, v189, 0
    v_mov_b32 v250, 0
    v_mov_b32 v251, 0
    s_mov_b32 s44, s14
    s_mov_b32 s45, s15
    s_mov_b32 s46, 2211840
    s_mov_b32 s47, 0x20000
    s_mov_b32 s24, s4
    s_mov_b32 s25, s5
    s_mov_b32 s26, 2621440
    s_mov_b32 s27, 0x20000
    s_mov_b32 s40, s16
    s_mov_b32 s41, s17
    s_mov_b32 s42, 2621440
    s_mov_b32 s43, 0x20000
    v_mfma_f32_32x32x8_bf16 v[2:17], v[250:251], v[250:251], 0
    v_mfma_f32_32x32x8_bf16 v[18:33], v[250:251], v[250:251], 0
    v_mfma_f32_32x32x8_bf16 v[34:49], v[250:251], v[250:251], 0
    v_mfma_f32_32x32x8_bf16 v[50:65], v[250:251], v[250:251], 0
    s_add_u32 s76, s76, 4
    s_mov_b64 exec, 1
    v_mov_b32 v244, 158724
    v_mov_b32 v245, 1
    ds_add_u32 v244, v245
    s_mov_b32 s83, 0x400000
SB_11:
    ds_read_b32 v245, v244
    s_sub_u32 s83, s83, 1
    s_cbranch_scc1 L_END
    s_waitcnt lgkmcnt(0)
    v_cmp_le_u32 vcc, s76, v245
    s_cbranch_vccz SB_11
    s_mov_b64 exec, -1
    v_lshlrev_b32 v250, 4, v1
    v_add_u32 v254, s89, v250
    v_lshrrev_b32 v244, 4, v1
    v_and_b32 v245, 15, v1
    v_lshlrev_b32 v244, 7, v244
    v_lshl_add_u32 v251, v245, 3, v244
    s_lshl_b32 s58, s51, 12
    v_add_u32 v250, s58, v250
    s_lshl_b32 s58, s51, 10
    s_add_u32 s58, s58, 16384
    v_add_u32 v251, s58, v251
    v_mov_b32 v244, 158732
    s_mov_b32 s83, 0x400000
LW_13:
    ds_read_b32 v245, v244
    s_sub_u32 s83, s83, 1
    s_cbranch_scc1 L_END
    s_sleep 1
    s_waitcnt lgkmcnt(0)
    v_cmp_le_u32 vcc, 4, v245
    s_cbranch_vccz LW_13
    buffer_store_dwordx4 v[130:133], v226, s[36:39], s87 offen offset:0 sc1
    buffer_store_dwordx4 v[138:141], v226, s[36:39], s87 offen offset:1024 sc1
    s_add_u32 s87, s87, 55296
    buffer_store_dwordx4 v[146:149], v226, s[36:39], s87 offen offset:0 sc1
    buffer_store_dwordx4 v[154:157], v226, s[36:39], s87 offen offset:1024 sc1
    s_add_u32 s87, s87, 55296
    buffer_store_dwordx4 v[162:165], v226, s[36:39], s87 offen offset:0 sc1
    buffer_store_dwordx4 v[170:173], v226, s[36:39], s87 offen offset:1024 sc1
    s_add_u32 s87, s87, 55296
    buffer_store_dwordx4 v[178:181], v226, s[36:39], s87 offen offset:0 sc1
    buffer_store_dwordx4 v[186:189], v226, s[36:39], s87 offen offset:1024 sc1
    s_waitcnt vmcnt(0)
    s_setprio 2
    s_mov_b64 exec, 15
    v_mov_b32 v244, s64
    v_mov_b32 v245, s65
    v_mov_b32 v246, s64
    v_mov_b32 v247, s65
    v_lshlrev_b32 v248, 4, v1
    buffer_store_dwordx4 v[244:247], v248, s[36:39], s85 offen sc1
    s_mov_b64 exec, -1
    s_setprio 0
    s_and_b32 s62, s80, 1
    s_mul_i32 s58, s62, 5120
    s_add_u32 s58, s58, 15360
    s_add_u32 m0, s89, s58
    s_xor_b32 s62, s62, 1
    buffer_load_dwordx4 v232, s[44:47], s81 offen offset:0 lds
    buffer_load_dwordx4 v233, s[44:47], s81 offen offset:1024 lds
    buffer_load_dwordx4 v234, s[44:47], s81 offen offset:2048 lds
    buffer_load_dwordx4 v235, s[44:47], s81 offen offset:3072 lds
    s_add_u32 m0, m0, 4096
    s_nop 0
    buffer_load_dwordx4 v236, s[44:47], s81 offen offset:0 lds
    s_add_u32 s81, s81, 40960
    s_waitcnt vmcnt(2)
    s_mul_i32 s58, s62, 5120
    s_add_u32 s58, s58, 15360
    s_add_u32 m0, s89, s58
    s_xor_b32 s62, s62, 1
    buffer_load_dwordx4 v232, s[44:47], s81 offen offset:0 lds
    buffer_load_dwordx4 v233, s[44:47], s81 offen offset:1024 lds
    buffer_load_dwordx4 v234, s[44:47], s81 offen offset:2048 lds
    buffer_load_dwordx4 v235, s[44:47], s81 offen offset:3072 lds
    s_add_u32 m0, m0, 4096
    s_nop 0
    buffer_load_dwordx4 v236, s[44:47], s81 offen offset:0 lds
    s_add_u32 s81, s81, 40960
    s_waitcnt vmcnt(2)
    buffer_load_dwordx2 v[196:197], v252, s[24:27], 0 offen offset:0
    buffer_load_dwordx2 v[198:199], v252, s[24:27], 0 offen offset:32
    buffer_load_dwordx2 v[200:201], v252, s[24:27], 0 offen offset:64
    buffer_load_dwordx2 v[202:203], v252, s[24:27], 0 offen offset:96
    buffer_load_dwordx2 v[204:205], v252, s[24:27], 0 offen offset:128
    s_mov_b32 s83, 0x100000
PL_14:
    buffer_load_dwordx2 v[194:195], v253, s[36:39], 0 offen sc1
    s_sub_u32 s83, s83, 1
    s_cbranch_scc1 L_END
    s_waitcnt vmcnt(0)
    v_cmp_eq_u64 vcc, s[64:65], v[194:195]
    s_nop 1
    s_and_b32 s58, vcc_lo, s88
    s_cmp_eq_u32 s58, s88
    s_cbranch_scc1 PLD_15
    s_sleep 8
    s_branch PL_14
PLD_15:
    s_setprio 2
    s_mov_b32 s62, s82
    s_mov_b32 s61, s89
    s_mov_b32 s32, s8
    s_mov_b32 s33, s9
    s_mov_b32 s34, 819200
    s_mov_b32 s35, 0x20000
    s_cmp_ge_u32 s51, 2
    s_cbranch_scc1 L_W2_E2
    buffer_load_dwordx4 v[82:85], v228, s[36:39], s79 offen sc1
    buffer_load_dwordx4 v[86:89], v229, s[36:39], s79 offen sc1
    buffer_load_dwordx4 v[90:93], v230, s[36:39], s79 offen sc1
    buffer_load_dwordx4 v[94:97], v231, s[36:39], s79 offen sc1
    s_add_u32 s79, s79, 1024
    buffer_load_dwordx4 v[98:101], v228, s[36:39], s79 offen sc1
    buffer_load_dwordx4 v[102:105], v229, s[36:39], s79 offen sc1
    buffer_load_dwordx4 v[106:109], v230, s[36:39], s79 offen sc1
    buffer_load_dwordx4 v[110:113], v231, s[36:39], s79 offen sc1
    s_add_u32 s79, s79, 1024
    ds_read_b64_tr_b16 v[130:131], v237 offset:15360
    ds_read_b64_tr_b16 v[132:133], v237 offset:17920
    ds_read_b64_tr_b16 v[134:135], v237 offset:15392
    ds_read_b64_tr_b16 v[136:137], v237 offset:17952
    ds_read_b64_tr_b16 v[138:139], v237 offset:15424
    ds_read_b64_tr_b16 v[140:141], v237 offset:17984
    ds_read_b64_tr_b16 v[142:143], v237 offset:15456
    ds_read_b64_tr_b16 v[144:145], v237 offset:18016
    ds_read_b64_tr_b16 v[146:147], v237 offset:15488
    ds_read_b64_tr_b16 v[148:149], v237 offset:18048
    s_branch L_W2_RES
L_W2_E2:
    buffer_load_dwordx4 v[98:101], v228, s[36:39], s79 offen sc1
    buffer_load_dwordx4 v[102:105], v229, s[36:39], s79 offen sc1
    buffer_load_dwordx4 v[106:109], v230, s[36:39], s79 offen sc1
    buffer_load_dwordx4 v[110:113], v231, s[36:39], s79 offen sc1
    s_add_u32 s79, s79, 1024
    buffer_load_dwordx4 v[82:85], v228, s[36:39], s79 offen sc1
    buffer_load_dwordx4 v[86:89], v229, s[36:39], s79 offen sc1
    buffer_load_dwordx4 v[90:93], v230, s[36:39], s79 offen sc1
    buffer_load_dwordx4 v[94:97], v231, s[36:39], s79 offen sc1
    s_add_u32 s79, s79, 1024
    ds_read_b64_tr_b16 v[150:151], v237 offset:20480
    ds_read_b64_tr_b16 v[152:153], v237 offset:23040
    ds_read_b64_tr_b16 v[154:155], v237 offset:20512
    ds_read_b64_tr_b16 v[156:157], v237 offset:23072
    ds_read_b64_tr_b16 v[158:159], v237 offset:20544
    ds_read_b64_tr_b16 v[160:161], v237 offset:23104
    ds_read_b64_tr_b16 v[162:163], v237 offset:20576
    ds_read_b64_tr_b16 v[164:165], v237 offset:23136
    ds_read_b64_tr_b16 v[166:167], v237 offset:20608
    ds_read_b64_tr_b16 v[168:169], v237 offset:23168
L_W2_RES:
    v_lshrrev_b32 v244, 3, v1
    v_cmp_eq_u32 vcc, s51, v244
    v_mov_b32 v244, 2147483648
    v_add_u32 v253, 65536, v253
    v_cndmask_b32 v253, v244, v253, vcc
    s_lshl_b32 s58, s51, 3
    s_lshl_b32 s88, 0xff, s58
    v_mov_b32 v249, 158724
    s_add_u32 s58, s51, 1
    s_and_b32 s58, s58, 3
    s_sub_u32 s58, s58, s51
    s_mul_i32 s58, s58, 25600
    v_add_u32 v246, s58, v254
    s_add_u32 s58, s51, 2
    s_and_b32 s58, s58, 3
    s_sub_u32 s58, s58, s51
    s_mul_i32 s58, s58, 25600
    v_add_u32 v247, s58, v254
    s_add_u32 s58, s51, 3
    s_and_b32 s58, s58, 3
    s_sub_u32 s58, s58, s51
    s_mul_i32 s58, s58, 25600
    v_add_u32 v248, s58, v254
    v_lshlrev_b32 v62, 16, v196
    v_and_b32 v63, s66, v196
    v_lshlrev_b32 v64, 16, v197
    v_and_b32 v65, s66, v197
    v_lshlrev_b32 v66, 16, v198
    v_and_b32 v67, s66, v198
    v_lshlrev_b32 v68, 16, v199
    v_and_b32 v69, s66, v199
    v_lshlrev_b32 v70, 16, v200
    v_and_b32 v71, s66, v200
    v_lshlrev_b32 v72, 16, v201
    v_and_b32 v73, s66, v201
    v_lshlrev_b32 v74, 16, v202
    v_and_b32 v75, s66, v202
    v_lshlrev_b32 v76, 16, v203
    v_and_b32 v77, s66, v203
    v_lshlrev_b32 v78, 16, v204
    v_and_b32 v79, s66, v204
    v_lshlrev_b32 v80, 16, v205
    v_and_b32 v81, s66, v205
    s_setprio 0
    s_waitcnt vmcnt(0)
    s_cmp_ge_u32 s51, 2
    s_cbranch_scc1 L_W2_1
.p2align 3
L_W2_0:
    s_waitcnt vmcnt(9) lgkmcnt(0)
    v_mfma_f32_16x16x32_bf16 v[2:5], v[130:133], v[82:85], v[2:5]
    s_add_u32 m0, s89, 15360
    v_mfma_f32_16x16x32_bf16 v[6:9], v[134:137], v[82:85], v[6:9]
    buffer_load_dwordx4 v232, s[44:47], s81 offen offset:0 lds
    v_mfma_f32_16x16x32_bf16 v[10:13], v[138:141], v[82:85], v[10:13]
    v_mfma_f32_16x16x32_bf16 v[14:17], v[142:145], v[82:85], v[14:17]
    buffer_load_dwordx4 v233, s[44:47], s81 offen offset:1024 lds
    v_mfma_f32_16x16x32_bf16 v[18:21], v[146:149], v[82:85], v[18:21]
    buffer_load_dwordx4 v[82:85], v228, s[36:39], s79 offen sc1
    v_mfma_f32_16x16x32_bf16 v[22:25], v[130:133], v[86:89], v[22:25]
    buffer_load_dwordx4 v234, s[44:47], s81 offen offset:2048 lds
    v_mfma_f32_16x16x32_bf16 v[26:29], v[134:137], v[86:89], v[26:29]
    v_mfma_f32_16x16x32_bf16 v[30:33], v[138:141], v[86:89], v[30:33]
    buffer_load_dwordx4 v235, s[44:47], s81 offen offset:3072 lds
    s_add_u32 m0, m0, 4096
    v_mfma_f32_16x16x32_bf16 v[34:37], v[142:145], v[86:89], v[34:37]
    v_mfma_f32_16x16x32_bf16 v[38:41], v[146:149], v[86:89], v[38:41]
    buffer_load_dwordx4 v236, s[44:47], s81 offen offset:0 lds
    buffer_load_dwordx4 v[86:89], v229, s[36:39], s79 offen sc1
    s_waitcnt vmcnt(10)
    v_mfma_f32_16x16x32_bf16 v[42:45], v[130:133], v[90:93], v[42:45]
    ds_read_b64_tr_b16 v[150:151], v237 offset:20480
    ds_read_b64_tr_b16 v[152:153], v237 offset:23040
    v_mfma_f32_16x16x32_bf16 v[46:49], v[134:137], v[90:93], v[46:49]
    v_mfma_f32_16x16x32_bf16 v[50:53], v[138:141], v[90:93], v[50:53]
    ds_read_b64_tr_b16 v[154:155], v237 offset:20512
    ds_read_b64_tr_b16 v[156:157], v237 offset:23072
    v_mfma_f32_16x16x32_bf16 v[54:57], v[142:145], v[90:93], v[54:57]
    v_mfma_f32_16x16x32_bf16 v[58:61], v[146:149], v[90:93], v[58:61]
    buffer_load_dwordx4 v[90:93], v230, s[36:39], s79 offen sc1
    ds_read_b64_tr_b16 v[158:159], v237 offset:20544
    ds_read_b64_tr_b16 v[160:161], v237 offset:23104
    v_mfma_f32_16x16x32_bf16 v[62:65], v[130:133], v[94:97], v[62:65]
    v_mfma_f32_16x16x32_bf16 v[66:69], v[134:137], v[94:97], v[66:69]
    ds_read_b64_tr_b16 v[162:163], v237 offset:20576
    ds_read_b64_tr_b16 v[164:165], v237 offset:23136
    v_mfma_f32_16x16x32_bf16 v[70:73], v[138:141], v[94:97], v[70:73]
    v_mfma_f32_16x16x32_bf16 v[74:77], v[142:145], v[94:97], v[74:77]
    ds_read_b64_tr_b16 v[166:167], v237 offset:20608
    ds_read_b64_tr_b16 v[168:169], v237 offset:23168
    v_mfma_f32_16x16x32_bf16 v[78:81], v[146:149], v[94:97], v[78:81]
    buffer_load_dwordx4 v[94:97], v231, s[36:39], s79 offen sc1
    s_add_u32 s81, s81, 40960
    s_add_u32 s79, s79, 1024
    s_sub_u32 s80, s80, 1
L_W2_1:
    s_waitcnt vmcnt(9) lgkmcnt(0)
    v_mfma_f32_16x16x32_bf16 v[2:5], v[150:153], v[98:101], v[2:5]
    s_add_u32 m0, s89, 20480
    v_mfma_f32_16x16x32_bf16 v[6:9], v[154:157], v[98:101], v[6:9]
    buffer_load_dwordx4 v232, s[44:47], s81 offen offset:0 lds
    v_mfma_f32_16x16x32_bf16 v[10:13], v[158:161], v[98:101], v[10:13]
    v_mfma_f32_16x16x32_bf16 v[14:17], v[162:165], v[98:101], v[14:17]
    buffer_load_dwordx4 v233, s[44:47], s81 offen offset:1024 lds
    v_mfma_f32_16x16x32_bf16 v[18:21], v[166:169], v[98:101], v[18:21]
    buffer_load_dwordx4 v[98:101], v228, s[36:39], s79 offen sc1
    v_mfma_f32_16x16x32_bf16 v[22:25], v[150:153], v[102:105], v[22:25]
    buffer_load_dwordx4 v234, s[44:47], s81 offen offset:2048 lds
    v_mfma_f32_16x16x32_bf16 v[26:29], v[154:157], v[102:105], v[26:29]
    v_mfma_f32_16x16x32_bf16 v[30:33], v[158:161], v[102:105], v[30:33]
    buffer_load_dwordx4 v235, s[44:47], s81 offen offset:3072 lds
    s_add_u32 m0, m0, 4096
    v_mfma_f32_16x16x32_bf16 v[34:37], v[162:165], v[102:105], v[34:37]
    v_mfma_f32_16x16x32_bf16 v[38:41], v[166:169], v[102:105], v[38:41]
    buffer_load_dwordx4 v236, s[44:47], s81 offen offset:0 lds
    buffer_load_dwordx4 v[102:105], v229, s[36:39], s79 offen sc1
    s_waitcnt vmcnt(10)
    v_mfma_f32_16x16x32_bf16 v[42:45], v[150:153], v[106:109], v[42:45]
    ds_read_b64_tr_b16 v[130:131], v237 offset:15360
    ds_read_b64_tr_b16 v[132:133], v237 offset:17920
    v_mfma_f32_16x16x32_bf16 v[46:49], v[154:157], v[106:109], v[46:49]
    v_mfma_f32_16x16x32_bf16 v[50:53], v[158:161], v[106:109], v[50:53]
    ds_read_b64_tr_b16 v[134:135], v237 offset:15392
    ds_read_b64_tr_b16 v[136:137], v237 offset:17952
    v_mfma_f32_16x16x32_bf16 v[54:57], v[162:165], v[106:109], v[54:57]
    v_mfma_f32_16x16x32_bf16 v[58:61], v[166:169], v[106:109], v[58:61]
    buffer_load_dwordx4 v[106:109], v230, s[36:39], s79 offen sc1
    ds_read_b64_tr_b16 v[138:139], v237 offset:15424
    ds_read_b64_tr_b16 v[140:141], v237 offset:17984
    v_mfma_f32_16x16x32_bf16 v[62:65], v[150:153], v[110:113], v[62:65]
    v_mfma_f32_16x16x32_bf16 v[66:69], v[154:157], v[110:113], v[66:69]
    ds_read_b64_tr_b16 v[142:143], v237 offset:15456
    ds_read_b64_tr_b16 v[144:145], v237 offset:18016
    v_mfma_f32_16x16x32_bf16 v[70:73], v[158:161], v[110:113], v[70:73]
    v_mfma_f32_16x16x32_bf16 v[74:77], v[162:165], v[110:113], v[74:77]
    ds_read_b64_tr_b16 v[146:147], v237 offset:15488
    ds_read_b64_tr_b16 v[148:149], v237 offset:18048
    v_mfma_f32_16x16x32_bf16 v[78:81], v[166:169], v[110:113], v[78:81]
    buffer_load_dwordx4 v[110:113], v231, s[36:39], s79 offen sc1
    s_add_u32 s81, s81, 40960
    s_add_u32 s79, s79, 1024
    s_sub_u32 s80, s80, 1
    s_cmp_le_u32 s80, 10
    s_cbranch_scc1 L_W2_X
L_W2_XD:
    s_cmp_lg_u32 s80, 0
    s_cbranch_scc1 L_W2_0
    v_mov_b32 v244, 158736
    s_mov_b32 s83, 0x400000
LW_16:
    ds_read_b32 v245, v244
    s_sub_u32 s83, s83, 1
    s_cbranch_scc1 L_END
    s_sleep 1
    s_waitcnt lgkmcnt(0)
    v_cmp_le_u32 vcc, 4, v245
    s_cbranch_vccz LW_16
    s_mov_b32 s83, 0x100000
PL_17:
    buffer_load_dwordx2 v[244:245], v253, s[36:39], 0 offen sc1
    s_sub_u32 s83, s83, 1
    s_cbranch_scc1 L_END
    s_waitcnt vmcnt(0)
    v_cmp_eq_u64 vcc, s[64:65], v[244:245]
    s_nop 1
    s_and_b32 s58, vcc_lo, s88
    s_cmp_eq_u32 s58, s88
    s_cbranch_scc0 PL_17
    buffer_load_dwordx4 v[182:185], v250, s[36:39], s98 offen offset:0 sc1
    buffer_load_dwordx4 v[186:189], v250, s[36:39], s98 offen offset:1024 sc1
    buffer_load_dwordx4 v[190:193], v250, s[36:39], s98 offen offset:2048 sc1
    buffer_load_dwordx4 v[194:197], v250, s[36:39], s98 offen offset:3072 sc1
    buffer_load_dwordx2 v[198:199], v251, s[36:39], s98 offen offset:0 sc1
    buffer_load_dwordx2 v[200:201], v251, s[36:39], s98 offen offset:512 sc1
    ds_read_b64_tr_b16 v[82:83], v242 offset:0
    ds_read_b64_tr_b16 v[84:85], v242 offset:1280
    ds_read_b64_tr_b16 v[86:87], v242 offset:32
    ds_read_b64_tr_b16 v[88:89], v242 offset:1312
    ds_read_b64_tr_b16 v[90:91], v242 offset:64
    ds_read_b64_tr_b16 v[92:93], v242 offset:1344
    ds_read_b64_tr_b16 v[94:95], v242 offset:96
    ds_read_b64_tr_b16 v[96:97], v242 offset:1376
    ds_read_b64_tr_b16 v[98:99], v242 offset:128
    ds_read_b64_tr_b16 v[100:101], v242 offset:1408
    buffer_load_dwordx4 v[202:205], v250, s[36:39], s99 offen offset:0 sc1
    buffer_load_dwordx4 v[206:209], v250, s[36:39], s99 offen offset:1024 sc1
    buffer_load_dwordx4 v[210:213], v250, s[36:39], s99 offen offset:2048 sc1
    buffer_load_dwordx4 v[214:217], v250, s[36:39], s99 offen offset:3072 sc1
    buffer_load_dwordx2 v[218:219], v251, s[36:39], s99 offen offset:0 sc1
    buffer_load_dwordx2 v[220:221], v251, s[36:39], s99 offen offset:512 sc1
    s_waitcnt lgkmcnt(5)
    ds_read_b64_tr_b16 v[102:103], v242 offset:6400
    ds_read_b64_tr_b16 v[104:105], v242 offset:7680
    ds_read_b64_tr_b16 v[106:107], v242 offset:6432
    ds_read_b64_tr_b16 v[108:109], v242 offset:7712
    ds_read_b64_tr_b16 v[110:111], v242 offset:6464
    ds_read_b64_tr_b16 v[112:113], v242 offset:7744
    ds_read_b64_tr_b16 v[114:115], v242 offset:6496
    ds_read_b64_tr_b16 v[116:117], v242 offset:7776
    ds_read_b64_tr_b16 v[118:119], v242 offset:6528
    ds_read_b64_tr_b16 v[120:121], v242 offset:7808
    buffer_load_dwordx4 v[222:225], v250, s[36:39], s100 offen offset:0 sc1
    buffer_load_dwordx4 v[226:229], v250, s[36:39], s100 offen offset:1024 sc1
    buffer_load_dwordx4 v[230:233], v250, s[36:39], s100 offen offset:2048 sc1
    buffer_load_dwordx4 v[234:237], v250, s[36:39], s100 offen offset:3072 sc1
    buffer_load_dwordx2 v[238:239], v251, s[36:39], s100 offen offset:0 sc1
    buffer_load_dwordx2 v[240:241], v251, s[36:39], s100 offen offset:512 sc1
    s_waitcnt lgkmcnt(5)
    ds_read_b64_tr_b16 v[122:123], v242 offset:12800
    ds_read_b64_tr_b16 v[124:125], v242 offset:14080
    ds_read_b64_tr_b16 v[126:127], v242 offset:12832
    ds_read_b64_tr_b16 v[128:129], v242 offset:14112
    ds_read_b64_tr_b16 v[130:131], v242 offset:12864
    ds_read_b64_tr_b16 v[132:133], v242 offset:14144
    ds_read_b64_tr_b16 v[134:135], v242 offset:12896
    ds_read_b64_tr_b16 v[136:137], v242 offset:14176
    ds_read_b64_tr_b16 v[138:139], v242 offset:12928
    ds_read_b64_tr_b16 v[140:141], v242 offset:14208
    s_waitcnt lgkmcnt(5)
    ds_read_b64_tr_b16 v[142:143], v242 offset:19200
    ds_read_b64_tr_b16 v[144:145], v242 offset:20480
    ds_read_b64_tr_b16 v[146:147], v242 offset:19232
    ds_read_b64_tr_b16 v[148:149], v242 offset:20512
    ds_read_b64_tr_b16 v[150:151], v242 offset:19264
    ds_read_b64_tr_b16 v[152:153], v242 offset:20544
    ds_read_b64_tr_b16 v[154:155], v242 offset:19296
    ds_read_b64_tr_b16 v[156:157], v242 offset:20576
    ds_read_b64_tr_b16 v[158:159], v242 offset:19328
    ds_read_b64_tr_b16 v[160:161], v242 offset:20608
    s_waitcnt lgkmcnt(5)
    ds_read_b64_tr_b16 v[162:163], v243 offset:0
    ds_read_b64_tr_b16 v[164:165], v243 offset:12800
    ds_read_b64_tr_b16 v[166:167], v243 offset:32
    ds_read_b64_tr_b16 v[168:169], v243 offset:12832
    ds_read_b64_tr_b16 v[170:171], v243 offset:64
    ds_read_b64_tr_b16 v[172:173], v243 offset:12864
    ds_read_b64_tr_b16 v[174:175], v243 offset:96
    ds_read_b64_tr_b16 v[176:177], v243 offset:12896
    ds_read_b64_tr_b16 v[178:179], v243 offset:128
    ds_read_b64_tr_b16 v[180:181], v243 offset:12928
    v_mov_b32 v244, 1
    s_mov_b32 s83, 0x400000
    s_waitcnt lgkmcnt(0)
    s_waitcnt vmcnt(12)
    v_mfma_f32_16x16x32_bf16 v[2:5], v[82:85], v[182:185], v[2:5]
    v_mfma_f32_16x16x32_bf16 v[6:9], v[86:89], v[182:185], v[6:9]
    v_mfma_f32_16x16x32_bf16 v[10:13], v[90:93], v[182:185], v[10:13]
    v_mfma_f32_16x16x32_bf16 v[14:17], v[94:97], v[182:185], v[14:17]
    v_mfma_f32_16x16x32_bf16 v[18:21], v[98:101], v[182:185], v[18:21]
    v_mfma_f32_16x16x32_bf16 v[2:5], v[102:105], v[186:189], v[2:5]
    v_mfma_f32_16x16x32_bf16 v[6:9], v[106:109], v[186:189], v[6:9]
    v_mfma_f32_16x16x32_bf16 v[10:13], v[110:113], v[186:189], v[10:13]
    v_mfma_f32_16x16x32_bf16 v[14:17], v[114:117], v[186:189], v[14:17]
    v_mfma_f32_16x16x32_bf16 v[18:21], v[118:121], v[186:189], v[18:21]
    v_mfma_f32_16x16x32_bf16 v[2:5], v[122:125], v[190:193], v[2:5]
    v_mfma_f32_16x16x32_bf16 v[6:9], v[126:129], v[190:193], v[6:9]
    v_mfma_f32_16x16x32_bf16 v[10:13], v[130:133], v[190:193], v[10:13]
    v_mfma_f32_16x16x32_bf16 v[14:17], v[134:137], v[190:193], v[14:17]
    v_mfma_f32_16x16x32_bf16 v[18:21], v[138:141], v[190:193], v[18:21]
    v_mfma_f32_16x16x32_bf16 v[2:5], v[142:145], v[194:197], v[2:5]
    v_mfma_f32_16x16x32_bf16 v[6:9], v[146:149], v[194:197], v[6:9]
    v_mfma_f32_16x16x32_bf16 v[10:13], v[150:153], v[194:197], v[10:13]
    v_mfma_f32_16x16x32_bf16 v[14:17], v[154:157], v[194:197], v[14:17]
    v_mfma_f32_16x16x32_bf16 v[18:21], v[158:161], v[194:197], v[18:21]
    v_mfma_f32_16x16x32_bf16 v[2:5], v[162:165], v[198:201], v[2:5]
    v_mfma_f32_16x16x32_bf16 v[6:9], v[166:169], v[198:201], v[6:9]
    v_mfma_f32_16x16x32_bf16 v[10:13], v[170:173], v[198:201], v[10:13]
    v_mfma_f32_16x16x32_bf16 v[14:17], v[174:177], v[198:201], v[14:17]
    v_mfma_f32_16x16x32_bf16 v[18:21], v[178:181], v[198:201], v[18:21]
    buffer_load_dwordx4 v[182:185], v250, s[36:39], s101 offen offset:0 sc1
    buffer_load_dwordx4 v[186:189], v250, s[36:39], s101 offen offset:1024 sc1
    buffer_load_dwordx4 v[190:193], v250, s[36:39], s101 offen offset:2048 sc1
    buffer_load_dwordx4 v[194:197], v250, s[36:39], s101 offen offset:3072 sc1
    buffer_load_dwordx2 v[198:199], v251, s[36:39], s101 offen offset:0 sc1
    buffer_load_dwordx2 v[200:201], v251, s[36:39], s101 offen offset:512 sc1
    s_waitcnt vmcnt(12)
    v_mfma_f32_16x16x32_bf16 v[22:25], v[82:85], v[202:205], v[22:25]
    v_mfma_f32_16x16x32_bf16 v[26:29], v[86:89], v[202:205], v[26:29]
    v_mfma_f32_16x16x32_bf16 v[30:33], v[90:93], v[202:205], v[30:33]
    v_mfma_f32_16x16x32_bf16 v[34:37], v[94:97], v[202:205], v[34:37]
    v_mfma_f32_16x16x32_bf16 v[38:41], v[98:101], v[202:205], v[38:41]
    v_mfma_f32_16x16x32_bf16 v[22:25], v[102:105], v[206:209], v[22:25]
    v_mfma_f32_16x16x32_bf16 v[26:29], v[106:109], v[206:209], v[26:29]
    ds_write_b128 v254, v[2:5] offset:0
    v_mfma_f32_16x16x32_bf16 v[30:33], v[110:113], v[206:209], v[30:33]
    v_mfma_f32_16x16x32_bf16 v[34:37], v[114:117], v[206:209], v[34:37]
    v_mfma_f32_16x16x32_bf16 v[38:41], v[118:121], v[206:209], v[38:41]
    ds_write_b128 v254, v[6:9] offset:1024
    v_mfma_f32_16x16x32_bf16 v[22:25], v[122:125], v[210:213], v[22:25]
    v_mfma_f32_16x16x32_bf16 v[26:29], v[126:129], v[210:213], v[26:29]
    v_mfma_f32_16x16x32_bf16 v[30:33], v[130:133], v[210:213], v[30:33]
    ds_write_b128 v254, v[10:13] offset:2048
    v_mfma_f32_16x16x32_bf16 v[34:37], v[134:137], v[210:213], v[34:37]
    v_mfma_f32_16x16x32_bf16 v[38:41], v[138:141], v[210:213], v[38:41]
    v_mfma_f32_16x16x32_bf16 v[22:25], v[142:145], v[214:217], v[22:25]
    ds_write_b128 v254, v[14:17] offset:3072
    v_mfma_f32_16x16x32_bf16 v[26:29], v[146:149], v[214:217], v[26:29]
    v_mfma_f32_16x16x32_bf16 v[30:33], v[150:153], v[214:217], v[30:33]
    v_mfma_f32_16x16x32_bf16 v[34:37], v[154:157], v[214:217], v[34:37]
    ds_write_b128 v254, v[18:21] offset:4096
    v_mfma_f32_16x16x32_bf16 v[38:41], v[158:161], v[214:217], v[38:41]
    v_mfma_f32_16x16x32_bf16 v[22:25], v[162:165], v[218:221], v[22:25]
    v_mfma_f32_16x16x32_bf16 v[26:29], v[166:169], v[218:221], v[26:29]
    v_mfma_f32_16x16x32_bf16 v[30:33], v[170:173], v[218:221], v[30:33]
    v_mfma_f32_16x16x32_bf16 v[34:37], v[174:177], v[218:221], v[34:37]
    v_mfma_f32_16x16x32_bf16 v[38:41], v[178:181], v[218:221], v[38:41]
    s_waitcnt vmcnt(6)
    v_mfma_f32_16x16x32_bf16 v[42:45], v[82:85], v[222:225], v[42:45]
    v_mfma_f32_16x16x32_bf16 v[46:49], v[86:89], v[222:225], v[46:49]
    v_mfma_f32_16x16x32_bf16 v[50:53], v[90:93], v[222:225], v[50:53]
    v_mfma_f32_16x16x32_bf16 v[54:57], v[94:97], v[222:225], v[54:57]
    v_mfma_f32_16x16x32_bf16 v[58:61], v[98:101], v[222:225], v[58:61]
    v_mfma_f32_16x16x32_bf16 v[42:45], v[102:105], v[226:229], v[42:45]
    v_mfma_f32_16x16x32_bf16 v[46:49], v[106:109], v[226:229], v[46:49]
    ds_write_b128 v254, v[22:25] offset:5120
    v_mfma_f32_16x16x32_bf16 v[50:53], v[110:113], v[226:229], v[50:53]
    v_mfma_f32_16x16x32_bf16 v[54:57], v[114:117], v[226:229], v[54:57]
    v_mfma_f32_16x16x32_bf16 v[58:61], v[118:121], v[226:229], v[58:61]
    ds_write_b128 v254, v[26:29] offset:6144
    v_mfma_f32_16x16x32_bf16 v[42:45], v[122:125], v[230:233], v[42:45]
    v_mfma_f32_16x16x32_bf16 v[46:49], v[126:129], v[230:233], v[46:49]
    v_mfma_f32_16x16x32_bf16 v[50:53], v[130:133], v[230:233], v[50:53]
    ds_write_b128 v254, v[30:33] offset:7168
    v_mfma_f32_16x16x32_bf16 v[54:57], v[134:137], v[230:233], v[54:57]
    v_mfma_f32_16x16x32_bf16 v[58:61], v[138:141], v[230:233], v[58:61]
    v_mfma_f32_16x16x32_bf16 v[42:45], v[142:145], v[234:237], v[42:45]
    ds_write_b128 v254, v[34:37] offset:8192
    v_mfma_f32_16x16x32_bf16 v[46:49], v[146:149], v[234:237], v[46:49]
    v_mfma_f32_16x16x32_bf16 v[50:53], v[150:153], v[234:237], v[50:53]
    v_mfma_f32_16x16x32_bf16 v[54:57], v[154:157], v[234:237], v[54:57]
    ds_write_b128 v254, v[38:41] offset:9216
    v_mfma_f32_16x16x32_bf16 v[58:61], v[158:161], v[234:237], v[58:61]
    v_mfma_f32_16x16x32_bf16 v[42:45], v[162:165], v[238:241], v[42:45]
    v_mfma_f32_16x16x32_bf16 v[46:49], v[166:169], v[238:241], v[46:49]
    v_mfma_f32_16x16x32_bf16 v[50:53], v[170:173], v[238:241], v[50:53]
    v_mfma_f32_16x16x32_bf16 v[54:57], v[174:177], v[238:241], v[54:57]
    v_mfma_f32_16x16x32_bf16 v[58:61], v[178:181], v[238:241], v[58:61]
    s_waitcnt vmcnt(0)
    v_mfma_f32_16x16x32_bf16 v[62:65], v[82:85], v[182:185], v[62:65]
    v_mfma_f32_16x16x32_bf16 v[66:69], v[86:89], v[182:185], v[66:69]
    v_mfma_f32_16x16x32_bf16 v[70:73], v[90:93], v[182:185], v[70:73]
    v_mfma_f32_16x16x32_bf16 v[74:77], v[94:97], v[182:185], v[74:77]
    v_mfma_f32_16x16x32_bf16 v[78:81], v[98:101], v[182:185], v[78:81]
    ds_write_b128 v254, v[42:45] offset:10240
    v_mfma_f32_16x16x32_bf16 v[62:65], v[102:105], v[186:189], v[62:65]
    ds_write_b128 v254, v[46:49] offset:11264
    v_mfma_f32_16x16x32_bf16 v[66:69], v[106:109], v[186:189], v[66:69]
    ds_write_b128 v254, v[50:53] offset:12288
    v_mfma_f32_16x16x32_bf16 v[70:73], v[110:113], v[186:189], v[70:73]
    ds_write_b128 v254, v[54:57] offset:13312
    v_mfma_f32_16x16x32_bf16 v[74:77], v[114:117], v[186:189], v[74:77]
    ds_write_b128 v254, v[58:61] offset:14336
    v_mfma_f32_16x16x32_bf16 v[78:81], v[118:121], v[186:189], v[78:81]
    s_mov_b64 exec, 1
    ds_add_u32 v249, v244
    s_mov_b64 exec, -1
    v_mfma_f32_16x16x32_bf16 v[62:65], v[122:125], v[190:193], v[62:65]
    v_mfma_f32_16x16x32_bf16 v[66:69], v[126:129], v[190:193], v[66:69]
    v_mfma_f32_16x16x32_bf16 v[70:73], v[130:133], v[190:193], v[70:73]
    ds_read_b32 v245, v249
    v_mfma_f32_16x16x32_bf16 v[74:77], v[134:137], v[190:193], v[74:77]
    v_mfma_f32_16x16x32_bf16 v[78:81], v[138:141], v[190:193], v[78:81]
    v_mfma_f32_16x16x32_bf16 v[62:65], v[142:145], v[194:197], v[62:65]
    v_mfma_f32_16x16x32_bf16 v[66:69], v[146:149], v[194:197], v[66:69]
    v_mfma_f32_16x16x32_bf16 v[70:73], v[150:153], v[194:197], v[70:73]
    v_mfma_f32_16x16x32_bf16 v[74:77], v[154:157], v[194:197], v[74:77]
L_YW:
    s_waitcnt lgkmcnt(0)
    v_cmp_le_u32 vcc, 8, v245
    s_cbranch_vccz L_YW2
    ds_read_b128 v[2:5], v246 offset:10240
    ds_read_b128 v[6:9], v246 offset:11264
    ds_read_b128 v[10:13], v246 offset:12288
    v_mfma_f32_16x16x32_bf16 v[78:81], v[158:161], v[194:197], v[78:81]
    ds_read_b128 v[14:17], v246 offset:13312
    ds_read_b128 v[18:21], v246 offset:14336
    v_mfma_f32_16x16x32_bf16 v[62:65], v[162:165], v[198:201], v[62:65]
    ds_read_b128 v[22:25], v247 offset:5120
    ds_read_b128 v[26:29], v247 offset:6144
    v_mfma_f32_16x16x32_bf16 v[66:69], v[166:169], v[198:201], v[66:69]
    ds_read_b128 v[30:33], v247 offset:7168
    ds_read_b128 v[34:37], v247 offset:8192
    v_mfma_f32_16x16x32_bf16 v[70:73], v[170:173], v[198:201], v[70:73]
    ds_read_b128 v[38:41], v247 offset:9216
    ds_read_b128 v[42:45], v248 offset:0
    v_mfma_f32_16x16x32_bf16 v[74:77], v[174:177], v[198:201], v[74:77]
    ds_read_b128 v[46:49], v248 offset:1024
    ds_read_b128 v[50:53], v248 offset:2048
    v_mfma_f32_16x16x32_bf16 v[78:81], v[178:181], v[198:201], v[78:81]
    ds_read_b128 v[54:57], v248 offset:3072
    ds_read_b128 v[58:61], v248 offset:4096
    s_waitcnt lgkmcnt(5)
    v_pk_add_f32 v[2:3], v[2:3], v[22:23]
    v_pk_add_f32 v[4:5], v[4:5], v[24:25]
    v_pk_add_f32 v[6:7], v[6:7], v[26:27]
    v_pk_add_f32 v[8:9], v[8:9], v[28:29]
    v_pk_add_f32 v[10:11], v[10:11], v[30:31]
    v_pk_add_f32 v[12:13], v[12:13], v[32:33]
    v_pk_add_f32 v[14:15], v[14:15], v[34:35]
    v_pk_add_f32 v[16:17], v[16:17], v[36:37]
    v_pk_add_f32 v[18:19], v[18:19], v[38:39]
    v_pk_add_f32 v[20:21], v[20:21], v[40:41]
    s_waitcnt lgkmcnt(0)
    v_pk_add_f32 v[62:63], v[62:63], v[42:43]
    v_pk_add_f32 v[64:65], v[64:65], v[44:45]
    v_pk_add_f32 v[66:67], v[66:67], v[46:47]
    v_pk_add_f32 v[68:69], v[68:69], v[48:49]
    v_pk_add_f32 v[70:71], v[70:71], v[50:51]
    v_pk_add_f32 v[72:73], v[72:73], v[52:53]
    v_pk_add_f32 v[74:75], v[74:75], v[54:55]
    v_pk_add_f32 v[76:77], v[76:77], v[56:57]
    v_pk_add_f32 v[78:79], v[78:79], v[58:59]
    v_pk_add_f32 v[80:81], v[80:81], v[60:61]
    v_pk_add_f32 v[62:63], v[62:63], v[2:3]
    v_pk_add_f32 v[64:65], v[64:65], v[4:5]
    v_pk_add_f32 v[66:67], v[66:67], v[6:7]
    v_pk_add_f32 v[68:69], v[68:69], v[8:9]
    v_pk_add_f32 v[70:71], v[70:71], v[10:11]
    v_pk_add_f32 v[72:73], v[72:73], v[12:13]
    v_pk_add_f32 v[74:75], v[74:75], v[14:15]
    v_pk_add_f32 v[76:77], v[76:77], v[16:17]
    v_pk_add_f32 v[78:79], v[78:79], v[18:19]
    v_pk_add_f32 v[80:81], v[80:81], v[20:21]
    v_cvt_pk_bf16_f32 v62, v62, v63
    v_cvt_pk_bf16_f32 v63, v64, v65
    buffer_store_dwordx2 v[62:63], v252, s[40:43], 0 offen offset:0
    v_cvt_pk_bf16_f32 v66, v66, v67
    v_cvt_pk_bf16_f32 v67, v68, v69
    buffer_store_dwordx2 v[66:67], v252, s[40:43], 0 offen offset:32
    v_cvt_pk_bf16_f32 v70, v70, v71
    v_cvt_pk_bf16_f32 v71, v72, v73
    buffer_store_dwordx2 v[70:71], v252, s[40:43], 0 offen offset:64
    v_cvt_pk_bf16_f32 v74, v74, v75
    v_cvt_pk_bf16_f32 v75, v76, v77
    buffer_store_dwordx2 v[74:75], v252, s[40:43], 0 offen offset:96
    v_cvt_pk_bf16_f32 v78, v78, v79
    v_cvt_pk_bf16_f32 v79, v80, v81
    buffer_store_dwordx2 v[78:79], v252, s[40:43], 0 offen offset:128
    s_cmp_eq_u32 s2, 0
    s_cbranch_scc0 L_NOEP
    s_cmp_eq_u32 s48, 4
    s_cbranch_scc0 L_NOEP
    s_mov_b32 s59, 19070976
    s_mov_b64 exec, 15
    v_mov_b32 v244, s64
    v_mov_b32 v245, s65
    v_mov_b32 v246, s64
    v_mov_b32 v247, s65
    v_lshlrev_b32 v248, 4, v1
    buffer_store_dwordx4 v[244:247], v248, s[36:39], s59 offen sc1
    s_mov_b64 exec, -1
L_NOEP:
    s_branch L_FIN
L_W2_X:
    s_cmp_eq_u32 s80, 2
    s_cbranch_scc1 L_W2_SW
    s_cmp_lt_u32 s80, 6
    s_cbranch_scc1 L_W2_XD
    s_mov_b32 m0, s61
    s_add_u32 s61, s61, 5120
    buffer_load_dwordx4 v232, s[32:35], s62 offen offset:0 lds
    buffer_load_dwordx4 v233, s[32:35], s62 offen offset:1024 lds
    buffer_load_dwordx4 v234, s[32:35], s62 offen offset:2048 lds
    buffer_load_dwordx4 v235, s[32:35], s62 offen offset:3072 lds
    s_add_u32 m0, m0, 4096
    s_nop 0
    buffer_load_dwordx4 v236, s[32:35], s62 offen offset:0 lds
    s_add_u32 s62, s62, 40960
    s_branch L_W2_XD
L_W2_SW:
    s_mov_b32 s44, s8
    s_mov_b32 s45, s9
    s_mov_b32 s46, 819200
    s_mov_b32 s81, s62
    s_mov_b32 s79, 2147483648
    s_branch L_W2_XD
L_P1a_again:
    buffer_load_dwordx4 v[36:39], v82, s[36:39], 0 offen offset:0 sc1
    buffer_load_dwordx4 v[40:43], v82, s[36:39], 0 offen offset:1024 sc1
    buffer_load_dwordx4 v[44:47], v82, s[36:39], 0 offen offset:2048 sc1
    buffer_load_dwordx4 v[48:51], v82, s[36:39], 0 offen offset:3072 sc1
    buffer_load_dwordx2 v[52:53], v83, s[36:39], 0 offen offset:0 sc1
    buffer_load_dwordx2 v[54:55], v83, s[36:39], 0 offen offset:512 sc1
    buffer_load_dwordx2 v[56:57], v83, s[36:39], 0 offen offset:1024 sc1
    buffer_load_dwordx2 v[58:59], v83, s[36:39], 0 offen offset:1536 sc1
    buffer_load_dwordx2 v[60:61], v83, s[36:39], 0 offen offset:2048 sc1
    s_sub_u32 s83, s83, 1
    s_cbranch_scc1 L_END
    s_waitcnt vmcnt(0)
    s_branch L_P1a_chk
L_P1b_again:
    buffer_load_dwordx4 v[36:39], v82, s[36:39], 0 offen offset:0 sc1
    buffer_load_dwordx4 v[40:43], v82, s[36:39], 0 offen offset:1024 sc1
    buffer_load_dwordx4 v[44:47], v82, s[36:39], 0 offen offset:2048 sc1
    buffer_load_dwordx4 v[48:51], v82, s[36:39], 0 offen offset:3072 sc1
    buffer_load_dwordx2 v[52:53], v83, s[36:39], 0 offen offset:0 sc1
    buffer_load_dwordx2 v[54:55], v83, s[36:39], 0 offen offset:512 sc1
    buffer_load_dwordx2 v[56:57], v83, s[36:39], 0 offen offset:1024 sc1
    buffer_load_dwordx2 v[58:59], v83, s[36:39], 0 offen offset:1536 sc1
    buffer_load_dwordx2 v[60:61], v83, s[36:39], 0 offen offset:2048 sc1
    s_sub_u32 s83, s83, 1
    s_cbranch_scc1 L_END
    s_waitcnt vmcnt(0)
    s_branch L_P1b_chk
L_YW2:
    ds_read_b32 v245, v249
    s_sub_u32 s83, s83, 1
    s_cbranch_scc1 L_END
    s_branch L_YW
L_FIN:
L_END:
    s_endpgm
.section .rodata,"a"
.p2align 6
.amdhsa_kernel parallel_sum__mha_block__dense_activation_relu__prompt_kernel
  .amdhsa_next_free_vgpr 256
  .amdhsa_next_free_sgpr 102
  .amdhsa_accum_offset 256
  .amdhsa_group_segment_fixed_size 0
  .amdhsa_kernarg_size 72
  .amdhsa_user_sgpr_count 2
  .amdhsa_user_sgpr_kernarg_segment_ptr 1
  .amdhsa_system_sgpr_workgroup_id_x 1
  .amdhsa_float_denorm_mode_32 3
.end_amdhsa_kernel
```
